```python
import torch

def _softmax(x, axis=-1):
    return torch.softmax(x, dim=axis)
def _gelu(x):
    return torch.nn.functional.gelu(x, approximate="tanh")
def _silu(x):
    return torch.nn.functional.silu(x)
def _sigmoid(x):
    return torch.sigmoid(x)
def _layernorm(x, axis=-1, eps=1e-5):
    m = x.mean(dim=axis, keepdim=True)
    v = x.var(dim=axis, keepdim=True, unbiased=False)
    return (x - m) / torch.sqrt(v + eps)
def _scatter_add(tgt, idx, src, axis=0):
    return tgt.clone().index_add_(axis, idx, src)
def _segment_sum(src, seg, n):
    out = torch.zeros((n,) + src.shape[1:], dtype=src.dtype)
    return out.index_add_(0, seg, src)
def _pad(x, pw):
    flat = tuple(v for pair in reversed(pw) for v in pair)
    return torch.nn.functional.pad(x, flat)

kernel_name = 'standalone__modern_conv_block_slak__vision'

def setup_inputs():

    _w = (lambda a: (lambda t: t.to(torch.bfloat16) if t.is_floating_point() else t)(torch.as_tensor(a)))
    H = W = 384
    C = 96
    K = 3
    return {
        "x": _w((lambda *s: torch.randn(*s, dtype=torch.bfloat16) * 0.05)(1, H, W, C)),
        "dw": _w((lambda *s: torch.randn(*s, dtype=torch.bfloat16) * 0.05)(K, K, C)),
        "w1": _w((lambda *s: torch.randn(*s, dtype=torch.bfloat16) * 0.05)(C, 4 * C)),
        "w2": _w((lambda *s: torch.randn(*s, dtype=torch.bfloat16) * 0.05)(4 * C, C)),
        "grn_g": _w((lambda *s: torch.randn(*s, dtype=torch.bfloat16) * 0.05)(4 * C)),
        "grn_b": _w((lambda *s: torch.randn(*s, dtype=torch.bfloat16) * 0.05)(4 * C)),
    }

def reference(x, dw, w1, w2, grn_g, grn_b):
    B, H, W, C = x.shape
    K = dw.shape[0]
    pad = K // 2
    xp = _pad(x, ((0,0),(pad,pad),(pad,pad),(0,0)))
    out = torch.zeros_like(x)
    for i in range(K):
        for j in range(K):
            out = out + xp[:, i:i+H, j:j+W, :] * dw[i, j][None, None, None, :]
    h = _layernorm(out, axis=-1)
    h = _gelu(h @ w1)
    gx = torch.sqrt((h * h).sum(axis=(1, 2), keepdims=True) + 1e-6)
    nx = gx / (gx.mean(axis=-1, keepdims=True) + 1e-6)
    h = grn_g[None, None, None, :] * (h * nx) + grn_b[None, None, None, :] + h
    return x + h @ w2
```

```asm
; @launch grid=(256,1,1) block=(512,1,1) lds=163840
.amdgcn_target "amdgcn-amd-amdhsa--gfx950"
.text
.globl standalone__modern_conv_block_slak__vision_kernel
.p2align 8
.type standalone__modern_conv_block_slak__vision_kernel,@function
standalone__modern_conv_block_slak__vision_kernel:
  s_cmp_ge_u32 s2, 256
  s_cbranch_scc1 L_END
  s_load_dwordx16 s[64:79], s[0:1], 0
  s_load_dwordx2 s[80:81], s[0:1], 64
  v_lshrrev_b32 v1, 6, v0
  v_and_b32 v2, 63, v0
  v_readfirstlane_b32 s40, v1
  s_getpc_b64 s[84:85]
L_PC:
  s_mov_b32 s86, L_END - L_PC + 4
  s_mov_b32 s87, 0x20000
  s_bfe_u32 s45, s2, 0x30003
  s_mul_i32 s45, s45, 6144
  v_lshlrev_b32 v3, 7, v0
  v_cmp_gt_u32 vcc, 48, v0
  s_and_saveexec_b64 s[46:47], vcc
  s_cbranch_execz L_CP
  buffer_load_dword v255, v3, s[84:87], s45 offen
L_CP:
  s_mov_b64 exec, -1
  s_and_b32 s45, s2, 7
  s_lshl_b32 s45, s45, 5
  s_lshr_b32 s46, s2, 3
  s_add_u32 s45, s45, s46
  s_lshr_b32 s46, s45, 3
  s_and_b32 s47, s45, 7
  s_mul_i32 s42, s46, 884736
  s_mul_i32 s48, s47, 9216
  s_add_u32 s42, s42, s48
  s_sub_u32 s43, s42, 73728
  s_cmp_eq_u32 s46, 0
  s_cselect_b32 s43, 0x80000000, s43
  s_add_u32 s44, s42, 884736
  s_cmp_eq_u32 s46, 31
  s_cselect_b32 s44, 0x80000000, s44
  s_and_b32 s41, s40, 3
  s_mov_b32 s50, 0x409d30fc
  s_mov_b32 s51, s50
  s_mov_b32 s52, 0x3c2aaaab
  s_mov_b32 s53, s52
  s_mov_b32 s54, 0x387ba882
  s_mov_b32 s55, s54
  s_mov_b32 s56, 0x3eeff558
  s_mov_b32 s57, 0x3727c5ac
  s_mov_b32 s6, 28311744
  s_mov_b32 s7, 0x20000
  s_mov_b32 s10, 28311552
  s_mov_b32 s11, 0x20000
  s_mov_b32 s14, 268435456
  s_mov_b32 s15, 0x20000
  s_mov_b32 s18, 73728
  s_mov_b32 s19, 0x20000
  s_mov_b32 s22, 73728
  s_mov_b32 s23, 0x20000
  s_mov_b32 s26, 1728
  s_mov_b32 s27, 0x20000
  s_mov_b32 s30, 768
  s_mov_b32 s31, 0x20000
  s_mov_b32 s34, 768
  s_mov_b32 s35, 0x20000
  s_mov_b32 s38, 256
  s_mov_b32 s39, 0x20000
  s_cmp_ge_u32 s40, 4
  s_cbranch_scc1 L_H
  v_and_b32 v3, 0x13, v2
  v_bfe_u32 v4, v2, 2, 1
  v_lshl_or_b32 v3, v4, 3, v3
  v_bfe_u32 v4, v2, 3, 1
  v_lshl_or_b32 v3, v4, 2, v3
  v_mul_u32_u24 v3, 208, v3
  v_lshrrev_b32 v4, 5, v2
  v_lshl_add_u32 v3, v4, 4, v3
  v_add_u32 v54, 147456, v3
  v_bfe_u32 v3, v2, 1, 2
  v_bfe_u32 v5, v2, 3, 1
  v_lshlrev_b32 v5, 1, v5
  v_xor_b32 v3, v3, v5
  v_xor_b32 v3, v3, v4
  v_and_b32 v5, 31, v2
  v_lshlrev_b32 v5, 6, v5
  v_lshl_add_u32 v3, v3, 4, v5
  s_mul_i32 s45, s41, 6144
  s_add_u32 s45, s45, 0
  v_add_u32 v55, s45, v3
  v_xor_b32 v56, 32, v55
  s_mul_i32 s45, s41, 192
  v_add_u32 v3, 0, v2
  v_mul_u32_u24 v4, 171, v3
  v_lshrrev_b32 v4, 11, v4
  v_mul_u32_u24 v5, 12, v4
  v_sub_u32 v5, v3, v5
  v_mul_u32_u24 v4, 768, v4
  v_lshl_add_u32 v8, v5, 4, v4
  v_add_u32 v8, s45, v8
  v_add_u32 v3, 64, v2
  v_mul_u32_u24 v4, 171, v3
  v_lshrrev_b32 v4, 11, v4
  v_mul_u32_u24 v5, 12, v4
  v_sub_u32 v5, v3, v5
  v_mul_u32_u24 v4, 768, v4
  v_lshl_add_u32 v9, v5, 4, v4
  v_add_u32 v9, s45, v9
  v_add_u32 v3, 128, v2
  v_mul_u32_u24 v4, 171, v3
  v_lshrrev_b32 v4, 11, v4
  v_mul_u32_u24 v5, 12, v4
  v_sub_u32 v5, v3, v5
  v_mul_u32_u24 v4, 768, v4
  v_lshl_add_u32 v10, v5, 4, v4
  v_add_u32 v10, s45, v10
  s_mul_i32 s46, s41, 18432
  s_add_u32 s46, s46, 24576
  s_waitcnt lgkmcnt(0)
  s_sub_u32 s4, s64, 192
  s_subb_u32 s5, s65, 0
  s_mov_b64 s[24:25], s[66:67]
  s_mov_b64 s[16:17], s[68:69]
  s_mov_b64 s[20:21], s[70:71]
  s_mov_b64 s[28:29], s[72:73]
  s_mov_b64 s[32:33], s[74:75]
  s_mov_b64 s[8:9], s[76:77]
  s_mov_b64 s[36:37], s[78:79]
  s_mov_b64 s[12:13], s[80:81]
  s_add_u32 m0, s46, 0
  s_mov_b32 s47, 0
  buffer_load_dwordx4 v8, s[16:19], s47 offen lds
  s_add_u32 m0, s46, 1024
  s_mov_b32 s47, 0
  buffer_load_dwordx4 v9, s[16:19], s47 offen lds
  s_add_u32 m0, s46, 2048
  s_mov_b32 s47, 0
  buffer_load_dwordx4 v10, s[16:19], s47 offen lds
  s_add_u32 m0, s46, 3072
  s_mov_b32 s47, 12288
  buffer_load_dwordx4 v8, s[16:19], s47 offen lds
  s_add_u32 m0, s46, 4096
  s_mov_b32 s47, 12288
  buffer_load_dwordx4 v9, s[16:19], s47 offen lds
  s_add_u32 m0, s46, 5120
  s_mov_b32 s47, 12288
  buffer_load_dwordx4 v10, s[16:19], s47 offen lds
  s_add_u32 m0, s46, 6144
  s_mov_b32 s47, 24576
  buffer_load_dwordx4 v8, s[16:19], s47 offen lds
  s_add_u32 m0, s46, 7168
  s_mov_b32 s47, 24576
  buffer_load_dwordx4 v9, s[16:19], s47 offen lds
  s_add_u32 m0, s46, 8192
  s_mov_b32 s47, 24576
  buffer_load_dwordx4 v10, s[16:19], s47 offen lds
  s_add_u32 m0, s46, 9216
  s_mov_b32 s47, 36864
  buffer_load_dwordx4 v8, s[16:19], s47 offen lds
  s_add_u32 m0, s46, 10240
  s_mov_b32 s47, 36864
  buffer_load_dwordx4 v9, s[16:19], s47 offen lds
  s_add_u32 m0, s46, 11264
  s_mov_b32 s47, 36864
  buffer_load_dwordx4 v10, s[16:19], s47 offen lds
  s_add_u32 m0, s46, 12288
  s_mov_b32 s47, 49152
  buffer_load_dwordx4 v8, s[16:19], s47 offen lds
  s_add_u32 m0, s46, 13312
  s_mov_b32 s47, 49152
  buffer_load_dwordx4 v9, s[16:19], s47 offen lds
  s_add_u32 m0, s46, 14336
  s_mov_b32 s47, 49152
  buffer_load_dwordx4 v10, s[16:19], s47 offen lds
  s_add_u32 m0, s46, 15360
  s_mov_b32 s47, 61440
  buffer_load_dwordx4 v8, s[16:19], s47 offen lds
  s_add_u32 m0, s46, 16384
  s_mov_b32 s47, 61440
  buffer_load_dwordx4 v9, s[16:19], s47 offen lds
  s_add_u32 m0, s46, 17408
  s_mov_b32 s47, 61440
  buffer_load_dwordx4 v10, s[16:19], s47 offen lds
  v_lshrrev_b32 v3, 4, v2
  v_lshlrev_b32 v3, 13, v3
  v_and_b32 v4, 15, v2
  v_lshl_add_u32 v60, v4, 2, v3
  v_cmp_gt_u32 vcc, 32, v2
  v_mov_b32 v4, 0x40000000
  s_nop 0
  v_cndmask_b32 v61, v4, v60, vcc
  s_bfe_u32 s86, s2, 0x10002
  s_mul_i32 s86, s86, 24
  s_mul_i32 s45, s41, 6
  s_add_u32 s86, s86, s45
  s_lshl_b32 s86, s86, 13
  s_lshr_b32 s45, s2, 3
  s_lshl_b32 s45, s45, 2
  s_and_b32 s87, s2, 3
  s_add_u32 s45, s45, s87
  s_lshl_b32 s45, s45, 6
  s_add_u32 s86, s86, s45
  s_add_u32 s87, s86, 32768
  v_lshrrev_b32 v3, 4, v2
  v_bfe_u32 v4, v2, 2, 2
  v_lshl_add_u32 v57, v3, 3, v4
  v_lshlrev_b32 v57, 6, v57
  v_and_b32 v3, 1, v3
  v_lshlrev_b32 v3, 1, v3
  v_lshrrev_b32 v4, 1, v4
  v_xor_b32 v3, v3, v4
  v_bfe_u32 v4, v2, 1, 1
  s_and_b32 s45, s41, 1
  s_lshl_b32 s45, s45, 1
  v_or_b32 v4, s45, v4
  v_xor_b32 v3, v3, v4
  v_lshl_add_u32 v57, v3, 4, v57
  v_and_b32 v4, 1, v2
  v_lshl_add_u32 v57, v4, 3, v57
  s_lshr_b32 s45, s41, 1
  s_mul_i32 s45, s45, 24576
  s_add_u32 s45, s45, 49152
  v_add_u32 v57, s45, v57
  v_xor_b32 v58, 32, v57
  v_add_u32 v58, 256, v58
  v_lshrrev_b32 v3, 5, v2
  v_bfe_u32 v4, v2, 2, 2
  v_lshl_add_u32 v3, v3, 3, v4
  v_mul_u32_u24 v3, 192, v3
  v_bfe_u32 v4, v2, 4, 1
  v_lshl_add_u32 v3, v4, 5, v3
  v_and_b32 v4, 3, v2
  v_lshl_add_u32 v3, v4, 3, v3
  v_add_u32 v3, s46, v3
  v_mov_b32 v48, 0
  v_mov_b32 v49, 0
  v_mov_b32 v50, 0
  v_mov_b32 v51, 0
  v_mov_b32 v52, 0
  v_mov_b32 v53, 0
  s_mov_b32 s58, 0
  s_mov_b32 s59, 49152
  s_mov_b32 s83, -9
  s_barrier
  s_waitcnt vmcnt(0)
  ds_read_b64_tr_b16 v[64:65], v3 offset:0
  ds_read_b64_tr_b16 v[66:67], v3 offset:768
  ds_read_b64_tr_b16 v[68:69], v3 offset:3072
  ds_read_b64_tr_b16 v[70:71], v3 offset:3840
  ds_read_b64_tr_b16 v[72:73], v3 offset:6144
  ds_read_b64_tr_b16 v[74:75], v3 offset:6912
  ds_read_b64_tr_b16 v[76:77], v3 offset:9216
  ds_read_b64_tr_b16 v[78:79], v3 offset:9984
  ds_read_b64_tr_b16 v[80:81], v3 offset:12288
  ds_read_b64_tr_b16 v[82:83], v3 offset:13056
  ds_read_b64_tr_b16 v[84:85], v3 offset:15360
  ds_read_b64_tr_b16 v[86:87], v3 offset:16128
  ds_read_b64_tr_b16 v[88:89], v3 offset:64
  ds_read_b64_tr_b16 v[90:91], v3 offset:832
  ds_read_b64_tr_b16 v[92:93], v3 offset:3136
  ds_read_b64_tr_b16 v[94:95], v3 offset:3904
  ds_read_b64_tr_b16 v[96:97], v3 offset:6208
  ds_read_b64_tr_b16 v[98:99], v3 offset:6976
  ds_read_b64_tr_b16 v[100:101], v3 offset:9280
  ds_read_b64_tr_b16 v[102:103], v3 offset:10048
  ds_read_b64_tr_b16 v[104:105], v3 offset:12352
  ds_read_b64_tr_b16 v[106:107], v3 offset:13120
  ds_read_b64_tr_b16 v[108:109], v3 offset:15424
  ds_read_b64_tr_b16 v[110:111], v3 offset:16192
  ds_read_b64_tr_b16 v[112:113], v3 offset:128
  ds_read_b64_tr_b16 v[114:115], v3 offset:896
  ds_read_b64_tr_b16 v[116:117], v3 offset:3200
  ds_read_b64_tr_b16 v[118:119], v3 offset:3968
  ds_read_b64_tr_b16 v[120:121], v3 offset:6272
  ds_read_b64_tr_b16 v[122:123], v3 offset:7040
  ds_read_b64_tr_b16 v[124:125], v3 offset:9344
  ds_read_b64_tr_b16 v[126:127], v3 offset:10112
  ds_read_b64_tr_b16 v[128:129], v3 offset:12416
  ds_read_b64_tr_b16 v[130:131], v3 offset:13184
  ds_read_b64_tr_b16 v[132:133], v3 offset:15488
  ds_read_b64_tr_b16 v[134:135], v3 offset:16256
  s_waitcnt lgkmcnt(0)
  s_barrier
  ds_read_b128 v[136:139], v54 offset:0
  ds_read_b128 v[140:143], v54 offset:32
  ds_read_b128 v[144:147], v54 offset:64
  ds_read_b128 v[148:151], v54 offset:96
  ds_read_b128 v[152:155], v54 offset:128
  ds_read_b128 v[156:159], v54 offset:160
  s_waitcnt lgkmcnt(5)
  v_mfma_f32_32x32x16_bf16 v[0:15], v[136:139], v[64:67], 0
  s_waitcnt lgkmcnt(4)
  v_mfma_f32_32x32x16_bf16 v[0:15], v[140:143], v[68:71], v[0:15]
  s_waitcnt lgkmcnt(3)
  v_mfma_f32_32x32x16_bf16 v[0:15], v[144:147], v[72:75], v[0:15]
  s_waitcnt lgkmcnt(2)
  v_mfma_f32_32x32x16_bf16 v[0:15], v[148:151], v[76:79], v[0:15]
  s_waitcnt lgkmcnt(1)
  v_mfma_f32_32x32x16_bf16 v[0:15], v[152:155], v[80:83], v[0:15]
  s_waitcnt lgkmcnt(0)
  v_mfma_f32_32x32x16_bf16 v[0:15], v[156:159], v[84:87], v[0:15]
  s_nop 12
  s_mov_b32 s52, 0xc1c00000
  s_mov_b32 s53, s52
  s_mov_b32 s54, 0x33800000
  s_mov_b32 s55, s54
  s_mov_b32 s82, 0x58000000
  s_getpc_b64 s[100:101]
L_PC2:
  s_cmp_ge_u32 s40, 2
  s_cbranch_scc1 L_GPRE1
  s_add_u32 s100, s100, L_GOWN_RET0 - L_PC2
  s_addc_u32 s101, s101, 0
  .p2align 6
L_GLOOP0:
  v_pk_fma_f32 v[32:33], v[0:1], v[0:1], s[50:51]
  v_pk_fma_f32 v[34:35], v[2:3], v[2:3], s[50:51]
  v_pk_fma_f32 v[36:37], v[4:5], v[4:5], s[50:51]
  v_pk_fma_f32 v[38:39], v[6:7], v[6:7], s[50:51]
  v_pk_fma_f32 v[40:41], v[8:9], v[8:9], s[50:51]
  v_pk_fma_f32 v[42:43], v[10:11], v[10:11], s[50:51]
  v_pk_fma_f32 v[44:45], v[12:13], v[12:13], s[50:51]
  v_pk_fma_f32 v[46:47], v[14:15], v[14:15], s[50:51]
  v_pk_fma_f32 v[32:33], v[0:1], v[32:33], s[52:53] neg_lo:[1,0,0] neg_hi:[1,0,0]
  v_pk_fma_f32 v[34:35], v[2:3], v[34:35], s[52:53] neg_lo:[1,0,0] neg_hi:[1,0,0]
  v_pk_fma_f32 v[36:37], v[4:5], v[36:37], s[52:53] neg_lo:[1,0,0] neg_hi:[1,0,0]
  v_pk_fma_f32 v[38:39], v[6:7], v[38:39], s[52:53] neg_lo:[1,0,0] neg_hi:[1,0,0]
  v_pk_fma_f32 v[40:41], v[8:9], v[40:41], s[52:53] neg_lo:[1,0,0] neg_hi:[1,0,0]
  v_pk_fma_f32 v[42:43], v[10:11], v[42:43], s[52:53] neg_lo:[1,0,0] neg_hi:[1,0,0]
  v_pk_fma_f32 v[44:45], v[12:13], v[44:45], s[52:53] neg_lo:[1,0,0] neg_hi:[1,0,0]
  v_pk_fma_f32 v[46:47], v[14:15], v[46:47], s[52:53] neg_lo:[1,0,0] neg_hi:[1,0,0]
  v_mfma_f32_32x32x16_bf16 v[16:31], v[136:139], v[88:91], 0
  v_exp_f32_e64 v32, v32 clamp
  v_exp_f32_e64 v33, v33 clamp
  v_exp_f32_e64 v34, v34 clamp
  v_mfma_f32_32x32x16_bf16 v[16:31], v[140:143], v[92:95], v[16:31]
  v_exp_f32_e64 v35, v35 clamp
  v_exp_f32_e64 v36, v36 clamp
  v_exp_f32_e64 v37, v37 clamp
  v_mfma_f32_32x32x16_bf16 v[16:31], v[144:147], v[96:99], v[16:31]
  v_exp_f32_e64 v38, v38 clamp
  v_exp_f32_e64 v39, v39 clamp
  v_exp_f32_e64 v40, v40 clamp
  v_mfma_f32_32x32x16_bf16 v[16:31], v[148:151], v[100:103], v[16:31]
  v_exp_f32_e64 v41, v41 clamp
  v_exp_f32_e64 v42, v42 clamp
  v_exp_f32_e64 v43, v43 clamp
  v_exp_f32_e64 v44, v44 clamp
  v_exp_f32_e64 v45, v45 clamp
  v_exp_f32_e64 v46, v46 clamp
  v_exp_f32_e64 v47, v47 clamp
  v_pk_add_f32 v[32:33], v[32:33], s[54:55]
  v_pk_add_f32 v[34:35], v[34:35], s[54:55]
  v_pk_add_f32 v[36:37], v[36:37], s[54:55]
  v_pk_add_f32 v[38:39], v[38:39], s[54:55]
  v_pk_add_f32 v[40:41], v[40:41], s[54:55]
  v_pk_add_f32 v[42:43], v[42:43], s[54:55]
  v_pk_add_f32 v[44:45], v[44:45], s[54:55]
  v_pk_add_f32 v[46:47], v[46:47], s[54:55]
  v_pk_mul_f32 v[0:1], v[0:1], v[34:35]
  v_pk_mul_f32 v[2:3], v[2:3], v[32:33]
  v_pk_mul_f32 v[4:5], v[4:5], v[38:39]
  v_pk_mul_f32 v[6:7], v[6:7], v[36:37]
  v_pk_mul_f32 v[8:9], v[8:9], v[42:43]
  v_pk_mul_f32 v[10:11], v[10:11], v[40:41]
  v_pk_mul_f32 v[12:13], v[12:13], v[46:47]
  v_pk_mul_f32 v[14:15], v[14:15], v[44:45]
  v_pk_mul_f32 v[32:33], v[32:33], v[34:35]
  v_pk_mul_f32 v[36:37], v[36:37], v[38:39]
  v_pk_mul_f32 v[40:41], v[40:41], v[42:43]
  v_pk_mul_f32 v[44:45], v[44:45], v[46:47]
  v_mfma_f32_32x32x16_bf16 v[16:31], v[152:155], v[104:107], v[16:31]
  v_rcp_f32_e32 v32, v32
  v_rcp_f32_e32 v33, v33
  v_rcp_f32_e32 v36, v36
  v_mfma_f32_32x32x16_bf16 v[16:31], v[156:159], v[108:111], v[16:31]
  v_rcp_f32_e32 v37, v37
  v_rcp_f32_e32 v40, v40
  v_rcp_f32_e32 v41, v41
  v_rcp_f32_e32 v44, v44
  v_rcp_f32_e32 v45, v45
  v_pk_mul_f32 v[0:1], v[0:1], v[32:33]
  v_pk_mul_f32 v[2:3], v[2:3], v[32:33]
  v_pk_mul_f32 v[4:5], v[4:5], v[36:37]
  v_pk_mul_f32 v[6:7], v[6:7], v[36:37]
  v_pk_mul_f32 v[8:9], v[8:9], v[40:41]
  v_pk_mul_f32 v[10:11], v[10:11], v[40:41]
  v_pk_mul_f32 v[12:13], v[12:13], v[44:45]
  v_pk_mul_f32 v[14:15], v[14:15], v[44:45]
  v_pk_fma_f32 v[48:49], v[0:1], v[0:1], v[48:49]
  v_cvt_pk_bf16_f32 v32, v0, v1
  v_pk_fma_f32 v[48:49], v[2:3], v[2:3], v[48:49]
  v_cvt_pk_bf16_f32 v33, v2, v3
  v_pk_fma_f32 v[48:49], v[4:5], v[4:5], v[48:49]
  v_cvt_pk_bf16_f32 v34, v4, v5
  v_pk_fma_f32 v[48:49], v[6:7], v[6:7], v[48:49]
  v_cvt_pk_bf16_f32 v35, v6, v7
  v_pk_fma_f32 v[48:49], v[8:9], v[8:9], v[48:49]
  v_cvt_pk_bf16_f32 v36, v8, v9
  v_pk_fma_f32 v[48:49], v[10:11], v[10:11], v[48:49]
  v_cvt_pk_bf16_f32 v37, v10, v11
  v_pk_fma_f32 v[48:49], v[12:13], v[12:13], v[48:49]
  v_cvt_pk_bf16_f32 v38, v12, v13
  v_pk_fma_f32 v[48:49], v[14:15], v[14:15], v[48:49]
  v_cvt_pk_bf16_f32 v39, v14, v15
  s_setprio 0
  ds_write_b128 v55, v[32:35] offset:0
  ds_write_b128 v56, v[36:39] offset:0
  s_nop 0
  v_pk_fma_f32 v[32:33], v[16:17], v[16:17], s[50:51]
  v_pk_fma_f32 v[34:35], v[18:19], v[18:19], s[50:51]
  v_pk_fma_f32 v[36:37], v[20:21], v[20:21], s[50:51]
  v_pk_fma_f32 v[38:39], v[22:23], v[22:23], s[50:51]
  v_pk_fma_f32 v[40:41], v[24:25], v[24:25], s[50:51]
  v_pk_fma_f32 v[42:43], v[26:27], v[26:27], s[50:51]
  v_pk_fma_f32 v[44:45], v[28:29], v[28:29], s[50:51]
  v_pk_fma_f32 v[46:47], v[30:31], v[30:31], s[50:51]
  v_pk_fma_f32 v[32:33], v[16:17], v[32:33], s[52:53] neg_lo:[1,0,0] neg_hi:[1,0,0]
  v_pk_fma_f32 v[34:35], v[18:19], v[34:35], s[52:53] neg_lo:[1,0,0] neg_hi:[1,0,0]
  v_pk_fma_f32 v[36:37], v[20:21], v[36:37], s[52:53] neg_lo:[1,0,0] neg_hi:[1,0,0]
  v_pk_fma_f32 v[38:39], v[22:23], v[38:39], s[52:53] neg_lo:[1,0,0] neg_hi:[1,0,0]
  v_pk_fma_f32 v[40:41], v[24:25], v[40:41], s[52:53] neg_lo:[1,0,0] neg_hi:[1,0,0]
  v_pk_fma_f32 v[42:43], v[26:27], v[42:43], s[52:53] neg_lo:[1,0,0] neg_hi:[1,0,0]
  v_pk_fma_f32 v[44:45], v[28:29], v[44:45], s[52:53] neg_lo:[1,0,0] neg_hi:[1,0,0]
  v_pk_fma_f32 v[46:47], v[30:31], v[46:47], s[52:53] neg_lo:[1,0,0] neg_hi:[1,0,0]
  v_mfma_f32_32x32x16_bf16 v[0:15], v[136:139], v[112:115], 0
  v_exp_f32_e64 v32, v32 clamp
  v_exp_f32_e64 v33, v33 clamp
  v_exp_f32_e64 v34, v34 clamp
  v_mfma_f32_32x32x16_bf16 v[0:15], v[140:143], v[116:119], v[0:15]
  v_exp_f32_e64 v35, v35 clamp
  v_exp_f32_e64 v36, v36 clamp
  v_exp_f32_e64 v37, v37 clamp
  v_mfma_f32_32x32x16_bf16 v[0:15], v[144:147], v[120:123], v[0:15]
  v_exp_f32_e64 v38, v38 clamp
  v_exp_f32_e64 v39, v39 clamp
  v_exp_f32_e64 v40, v40 clamp
  v_mfma_f32_32x32x16_bf16 v[0:15], v[148:151], v[124:127], v[0:15]
  v_exp_f32_e64 v41, v41 clamp
  v_exp_f32_e64 v42, v42 clamp
  v_exp_f32_e64 v43, v43 clamp
  v_exp_f32_e64 v44, v44 clamp
  v_exp_f32_e64 v45, v45 clamp
  v_exp_f32_e64 v46, v46 clamp
  v_exp_f32_e64 v47, v47 clamp
  v_pk_add_f32 v[32:33], v[32:33], s[54:55]
  v_pk_add_f32 v[34:35], v[34:35], s[54:55]
  v_pk_add_f32 v[36:37], v[36:37], s[54:55]
  v_pk_add_f32 v[38:39], v[38:39], s[54:55]
  v_pk_add_f32 v[40:41], v[40:41], s[54:55]
  v_pk_add_f32 v[42:43], v[42:43], s[54:55]
  v_pk_add_f32 v[44:45], v[44:45], s[54:55]
  v_pk_add_f32 v[46:47], v[46:47], s[54:55]
  v_pk_mul_f32 v[16:17], v[16:17], v[34:35]
  v_pk_mul_f32 v[18:19], v[18:19], v[32:33]
  v_pk_mul_f32 v[20:21], v[20:21], v[38:39]
  v_pk_mul_f32 v[22:23], v[22:23], v[36:37]
  v_pk_mul_f32 v[24:25], v[24:25], v[42:43]
  v_pk_mul_f32 v[26:27], v[26:27], v[40:41]
  v_pk_mul_f32 v[28:29], v[28:29], v[46:47]
  v_pk_mul_f32 v[30:31], v[30:31], v[44:45]
  v_pk_mul_f32 v[32:33], v[32:33], v[34:35]
  v_pk_mul_f32 v[36:37], v[36:37], v[38:39]
  v_pk_mul_f32 v[40:41], v[40:41], v[42:43]
  v_pk_mul_f32 v[44:45], v[44:45], v[46:47]
  v_mfma_f32_32x32x16_bf16 v[0:15], v[152:155], v[128:131], v[0:15]
  v_rcp_f32_e32 v32, v32
  v_rcp_f32_e32 v33, v33
  v_rcp_f32_e32 v36, v36
  v_mfma_f32_32x32x16_bf16 v[0:15], v[156:159], v[132:135], v[0:15]
  v_rcp_f32_e32 v37, v37
  s_setprio 2
  s_waitcnt lgkmcnt(0)
  v_rcp_f32_e32 v40, v40
  v_rcp_f32_e32 v41, v41
  s_barrier
  ds_read_b128 v[136:139], v54 offset:6656
  ds_read_b128 v[140:143], v54 offset:6688
  ds_read_b128 v[144:147], v54 offset:6720
  ds_read_b128 v[148:151], v54 offset:6752
  ds_read_b128 v[152:155], v54 offset:6784
  ds_read_b128 v[156:159], v54 offset:6816
  v_rcp_f32_e32 v44, v44
  v_rcp_f32_e64 v45, v45
  v_pk_mul_f32 v[16:17], v[16:17], v[32:33]
  v_pk_mul_f32 v[18:19], v[18:19], v[32:33]
  v_pk_mul_f32 v[20:21], v[20:21], v[36:37]
  v_pk_mul_f32 v[22:23], v[22:23], v[36:37]
  v_pk_mul_f32 v[24:25], v[24:25], v[40:41]
  v_pk_mul_f32 v[26:27], v[26:27], v[40:41]
  v_pk_mul_f32 v[28:29], v[28:29], v[44:45]
  v_pk_mul_f32 v[30:31], v[30:31], v[44:45]
  v_pk_fma_f32 v[50:51], v[16:17], v[16:17], v[50:51]
  v_cvt_pk_bf16_f32 v32, v16, v17
  v_pk_fma_f32 v[50:51], v[18:19], v[18:19], v[50:51]
  v_cvt_pk_bf16_f32 v33, v18, v19
  v_pk_fma_f32 v[50:51], v[20:21], v[20:21], v[50:51]
  v_cvt_pk_bf16_f32 v34, v20, v21
  v_pk_fma_f32 v[50:51], v[22:23], v[22:23], v[50:51]
  v_cvt_pk_bf16_f32 v35, v22, v23
  v_pk_fma_f32 v[50:51], v[24:25], v[24:25], v[50:51]
  v_cvt_pk_bf16_f32 v36, v24, v25
  v_pk_fma_f32 v[50:51], v[26:27], v[26:27], v[50:51]
  v_cvt_pk_bf16_f32 v37, v26, v27
  v_pk_fma_f32 v[50:51], v[28:29], v[28:29], v[50:51]
  v_cvt_pk_bf16_f32 v38, v28, v29
  v_pk_fma_f32 v[50:51], v[30:31], v[30:31], v[50:51]
  v_cvt_pk_bf16_f32 v39, v30, v31
  ds_write_b128 v55, v[32:35] offset:2048
  ds_write_b128 v56, v[36:39] offset:2048
  s_waitcnt lgkmcnt(2)
  s_nop 0
  v_pk_fma_f32 v[32:33], v[0:1], v[0:1], s[50:51]
  v_pk_fma_f32 v[34:35], v[2:3], v[2:3], s[50:51]
  v_pk_fma_f32 v[36:37], v[4:5], v[4:5], s[50:51]
  v_pk_fma_f32 v[38:39], v[6:7], v[6:7], s[50:51]
  v_pk_fma_f32 v[40:41], v[8:9], v[8:9], s[50:51]
  v_pk_fma_f32 v[42:43], v[10:11], v[10:11], s[50:51]
  v_pk_fma_f32 v[44:45], v[12:13], v[12:13], s[50:51]
  v_pk_fma_f32 v[46:47], v[14:15], v[14:15], s[50:51]
  v_pk_fma_f32 v[32:33], v[0:1], v[32:33], s[52:53] neg_lo:[1,0,0] neg_hi:[1,0,0]
  v_pk_fma_f32 v[34:35], v[2:3], v[34:35], s[52:53] neg_lo:[1,0,0] neg_hi:[1,0,0]
  v_pk_fma_f32 v[36:37], v[4:5], v[36:37], s[52:53] neg_lo:[1,0,0] neg_hi:[1,0,0]
  v_pk_fma_f32 v[38:39], v[6:7], v[38:39], s[52:53] neg_lo:[1,0,0] neg_hi:[1,0,0]
  v_pk_fma_f32 v[40:41], v[8:9], v[40:41], s[52:53] neg_lo:[1,0,0] neg_hi:[1,0,0]
  v_pk_fma_f32 v[42:43], v[10:11], v[42:43], s[52:53] neg_lo:[1,0,0] neg_hi:[1,0,0]
  v_pk_fma_f32 v[44:45], v[12:13], v[44:45], s[52:53] neg_lo:[1,0,0] neg_hi:[1,0,0]
  v_pk_fma_f32 v[46:47], v[14:15], v[46:47], s[52:53] neg_lo:[1,0,0] neg_hi:[1,0,0]
  v_mfma_f32_32x32x16_bf16 v[16:31], v[136:139], v[64:67], 0
  v_exp_f32_e64 v32, v32 clamp
  v_exp_f32_e64 v33, v33 clamp
  v_exp_f32_e64 v34, v34 clamp
  v_mfma_f32_32x32x16_bf16 v[16:31], v[140:143], v[68:71], v[16:31]
  v_exp_f32_e64 v35, v35 clamp
  v_exp_f32_e64 v36, v36 clamp
  v_exp_f32_e64 v37, v37 clamp
  v_mfma_f32_32x32x16_bf16 v[16:31], v[144:147], v[72:75], v[16:31]
  v_exp_f32_e64 v38, v38 clamp
  v_exp_f32_e64 v39, v39 clamp
  v_exp_f32_e64 v40, v40 clamp
  v_mfma_f32_32x32x16_bf16 v[16:31], v[148:151], v[76:79], v[16:31]
  v_exp_f32_e64 v41, v41 clamp
  v_exp_f32_e64 v42, v42 clamp
  v_exp_f32_e64 v43, v43 clamp
  v_exp_f32_e64 v44, v44 clamp
  v_exp_f32_e64 v45, v45 clamp
  v_exp_f32_e64 v46, v46 clamp
  v_exp_f32_e64 v47, v47 clamp
  v_pk_add_f32 v[32:33], v[32:33], s[54:55]
  v_pk_add_f32 v[34:35], v[34:35], s[54:55]
  v_pk_add_f32 v[36:37], v[36:37], s[54:55]
  v_pk_add_f32 v[38:39], v[38:39], s[54:55]
  v_pk_add_f32 v[40:41], v[40:41], s[54:55]
  v_pk_add_f32 v[42:43], v[42:43], s[54:55]
  v_pk_add_f32 v[44:45], v[44:45], s[54:55]
  v_pk_add_f32 v[46:47], v[46:47], s[54:55]
  v_pk_mul_f32 v[0:1], v[0:1], v[34:35]
  v_pk_mul_f32 v[2:3], v[2:3], v[32:33]
  v_pk_mul_f32 v[4:5], v[4:5], v[38:39]
  v_pk_mul_f32 v[6:7], v[6:7], v[36:37]
  v_pk_mul_f32 v[8:9], v[8:9], v[42:43]
  v_pk_mul_f32 v[10:11], v[10:11], v[40:41]
  v_pk_mul_f32 v[12:13], v[12:13], v[46:47]
  v_pk_mul_f32 v[14:15], v[14:15], v[44:45]
  v_pk_mul_f32 v[32:33], v[32:33], v[34:35]
  v_pk_mul_f32 v[36:37], v[36:37], v[38:39]
  v_pk_mul_f32 v[40:41], v[40:41], v[42:43]
  v_pk_mul_f32 v[44:45], v[44:45], v[46:47]
  v_mfma_f32_32x32x16_bf16 v[16:31], v[152:155], v[80:83], v[16:31]
  v_rcp_f32_e32 v32, v32
  v_rcp_f32_e32 v33, v33
  v_rcp_f32_e32 v36, v36
  v_mfma_f32_32x32x16_bf16 v[16:31], v[156:159], v[84:87], v[16:31]
  v_rcp_f32_e32 v37, v37
  v_rcp_f32_e32 v40, v40
  v_rcp_f32_e32 v41, v41
  v_rcp_f32_e32 v44, v44
  v_rcp_f32_e32 v45, v45
  v_pk_mul_f32 v[0:1], v[0:1], v[32:33]
  v_pk_mul_f32 v[2:3], v[2:3], v[32:33]
  v_pk_mul_f32 v[4:5], v[4:5], v[36:37]
  v_pk_mul_f32 v[6:7], v[6:7], v[36:37]
  v_pk_mul_f32 v[8:9], v[8:9], v[40:41]
  v_pk_mul_f32 v[10:11], v[10:11], v[40:41]
  v_pk_mul_f32 v[12:13], v[12:13], v[44:45]
  v_pk_mul_f32 v[14:15], v[14:15], v[44:45]
  v_pk_fma_f32 v[52:53], v[0:1], v[0:1], v[52:53]
  v_cvt_pk_bf16_f32 v32, v0, v1
  v_pk_fma_f32 v[52:53], v[2:3], v[2:3], v[52:53]
  v_cvt_pk_bf16_f32 v33, v2, v3
  v_pk_fma_f32 v[52:53], v[4:5], v[4:5], v[52:53]
  v_cvt_pk_bf16_f32 v34, v4, v5
  v_pk_fma_f32 v[52:53], v[6:7], v[6:7], v[52:53]
  v_cvt_pk_bf16_f32 v35, v6, v7
  v_pk_fma_f32 v[52:53], v[8:9], v[8:9], v[52:53]
  v_cvt_pk_bf16_f32 v36, v8, v9
  v_pk_fma_f32 v[52:53], v[10:11], v[10:11], v[52:53]
  v_cvt_pk_bf16_f32 v37, v10, v11
  v_pk_fma_f32 v[52:53], v[12:13], v[12:13], v[52:53]
  v_cvt_pk_bf16_f32 v38, v12, v13
  v_pk_fma_f32 v[52:53], v[14:15], v[14:15], v[52:53]
  v_cvt_pk_bf16_f32 v39, v14, v15
  ds_write_b128 v55, v[32:35] offset:4096
  ds_write_b128 v56, v[36:39] offset:4096
  s_bitcmp1_b32 s82, s83
  s_cbranch_scc1 L_GOWN
L_GOWN_RET0:
  v_pk_fma_f32 v[32:33], v[16:17], v[16:17], s[50:51]
  v_pk_fma_f32 v[34:35], v[18:19], v[18:19], s[50:51]
  v_pk_fma_f32 v[36:37], v[20:21], v[20:21], s[50:51]
  v_pk_fma_f32 v[38:39], v[22:23], v[22:23], s[50:51]
  v_pk_fma_f32 v[40:41], v[24:25], v[24:25], s[50:51]
  v_pk_fma_f32 v[42:43], v[26:27], v[26:27], s[50:51]
  v_pk_fma_f32 v[44:45], v[28:29], v[28:29], s[50:51]
  v_pk_fma_f32 v[46:47], v[30:31], v[30:31], s[50:51]
  v_pk_fma_f32 v[32:33], v[16:17], v[32:33], s[52:53] neg_lo:[1,0,0] neg_hi:[1,0,0]
  v_pk_fma_f32 v[34:35], v[18:19], v[34:35], s[52:53] neg_lo:[1,0,0] neg_hi:[1,0,0]
  v_pk_fma_f32 v[36:37], v[20:21], v[36:37], s[52:53] neg_lo:[1,0,0] neg_hi:[1,0,0]
  v_pk_fma_f32 v[38:39], v[22:23], v[38:39], s[52:53] neg_lo:[1,0,0] neg_hi:[1,0,0]
  v_pk_fma_f32 v[40:41], v[24:25], v[40:41], s[52:53] neg_lo:[1,0,0] neg_hi:[1,0,0]
  v_pk_fma_f32 v[42:43], v[26:27], v[42:43], s[52:53] neg_lo:[1,0,0] neg_hi:[1,0,0]
  v_pk_fma_f32 v[44:45], v[28:29], v[44:45], s[52:53] neg_lo:[1,0,0] neg_hi:[1,0,0]
  v_pk_fma_f32 v[46:47], v[30:31], v[46:47], s[52:53] neg_lo:[1,0,0] neg_hi:[1,0,0]
  v_mfma_f32_32x32x16_bf16 v[0:15], v[136:139], v[88:91], 0
  v_exp_f32_e64 v32, v32 clamp
  v_exp_f32_e64 v33, v33 clamp
  v_exp_f32_e64 v34, v34 clamp
  v_mfma_f32_32x32x16_bf16 v[0:15], v[140:143], v[92:95], v[0:15]
  v_exp_f32_e64 v35, v35 clamp
  v_exp_f32_e64 v36, v36 clamp
  v_exp_f32_e64 v37, v37 clamp
  v_mfma_f32_32x32x16_bf16 v[0:15], v[144:147], v[96:99], v[0:15]
  v_exp_f32_e64 v38, v38 clamp
  v_exp_f32_e64 v39, v39 clamp
  v_exp_f32_e64 v40, v40 clamp
  v_mfma_f32_32x32x16_bf16 v[0:15], v[148:151], v[100:103], v[0:15]
  v_exp_f32_e64 v41, v41 clamp
  v_exp_f32_e64 v42, v42 clamp
  v_exp_f32_e64 v43, v43 clamp
  v_exp_f32_e64 v44, v44 clamp
  v_exp_f32_e64 v45, v45 clamp
  v_exp_f32_e64 v46, v46 clamp
  v_exp_f32_e64 v47, v47 clamp
  v_pk_add_f32 v[32:33], v[32:33], s[54:55]
  v_pk_add_f32 v[34:35], v[34:35], s[54:55]
  v_pk_add_f32 v[36:37], v[36:37], s[54:55]
  v_pk_add_f32 v[38:39], v[38:39], s[54:55]
  v_pk_add_f32 v[40:41], v[40:41], s[54:55]
  v_pk_add_f32 v[42:43], v[42:43], s[54:55]
  v_pk_add_f32 v[44:45], v[44:45], s[54:55]
  v_pk_add_f32 v[46:47], v[46:47], s[54:55]
  v_pk_mul_f32 v[16:17], v[16:17], v[34:35]
  v_pk_mul_f32 v[18:19], v[18:19], v[32:33]
  v_pk_mul_f32 v[20:21], v[20:21], v[38:39]
  v_pk_mul_f32 v[22:23], v[22:23], v[36:37]
  v_pk_mul_f32 v[24:25], v[24:25], v[42:43]
  v_pk_mul_f32 v[26:27], v[26:27], v[40:41]
  v_pk_mul_f32 v[28:29], v[28:29], v[46:47]
  v_pk_mul_f32 v[30:31], v[30:31], v[44:45]
  v_pk_mul_f32 v[32:33], v[32:33], v[34:35]
  v_pk_mul_f32 v[36:37], v[36:37], v[38:39]
  v_pk_mul_f32 v[40:41], v[40:41], v[42:43]
  v_pk_mul_f32 v[44:45], v[44:45], v[46:47]
  v_mfma_f32_32x32x16_bf16 v[0:15], v[152:155], v[104:107], v[0:15]
  v_rcp_f32_e32 v32, v32
  v_rcp_f32_e32 v33, v33
  v_rcp_f32_e32 v36, v36
  v_mfma_f32_32x32x16_bf16 v[0:15], v[156:159], v[108:111], v[0:15]
  v_rcp_f32_e32 v37, v37
  v_rcp_f32_e32 v40, v40
  v_rcp_f32_e32 v41, v41
  v_rcp_f32_e32 v44, v44
  v_rcp_f32_e32 v45, v45
  v_pk_mul_f32 v[16:17], v[16:17], v[32:33]
  v_pk_mul_f32 v[18:19], v[18:19], v[32:33]
  v_pk_mul_f32 v[20:21], v[20:21], v[36:37]
  v_pk_mul_f32 v[22:23], v[22:23], v[36:37]
  v_pk_mul_f32 v[24:25], v[24:25], v[40:41]
  v_pk_mul_f32 v[26:27], v[26:27], v[40:41]
  v_pk_mul_f32 v[28:29], v[28:29], v[44:45]
  v_pk_mul_f32 v[30:31], v[30:31], v[44:45]
  v_pk_fma_f32 v[48:49], v[16:17], v[16:17], v[48:49]
  v_cvt_pk_bf16_f32 v32, v16, v17
  v_pk_fma_f32 v[48:49], v[18:19], v[18:19], v[48:49]
  v_cvt_pk_bf16_f32 v33, v18, v19
  v_pk_fma_f32 v[48:49], v[20:21], v[20:21], v[48:49]
  v_cvt_pk_bf16_f32 v34, v20, v21
  v_pk_fma_f32 v[48:49], v[22:23], v[22:23], v[48:49]
  v_cvt_pk_bf16_f32 v35, v22, v23
  v_pk_fma_f32 v[48:49], v[24:25], v[24:25], v[48:49]
  v_cvt_pk_bf16_f32 v36, v24, v25
  v_pk_fma_f32 v[48:49], v[26:27], v[26:27], v[48:49]
  v_cvt_pk_bf16_f32 v37, v26, v27
  v_pk_fma_f32 v[48:49], v[28:29], v[28:29], v[48:49]
  v_cvt_pk_bf16_f32 v38, v28, v29
  v_pk_fma_f32 v[48:49], v[30:31], v[30:31], v[48:49]
  v_cvt_pk_bf16_f32 v39, v30, v31
  s_setprio 0
  ds_write_b128 v55, v[32:35] offset:24576
  ds_write_b128 v56, v[36:39] offset:24576
  s_nop 0
  v_pk_fma_f32 v[32:33], v[0:1], v[0:1], s[50:51]
  v_pk_fma_f32 v[34:35], v[2:3], v[2:3], s[50:51]
  v_pk_fma_f32 v[36:37], v[4:5], v[4:5], s[50:51]
  v_pk_fma_f32 v[38:39], v[6:7], v[6:7], s[50:51]
  v_pk_fma_f32 v[40:41], v[8:9], v[8:9], s[50:51]
  v_pk_fma_f32 v[42:43], v[10:11], v[10:11], s[50:51]
  v_pk_fma_f32 v[44:45], v[12:13], v[12:13], s[50:51]
  v_pk_fma_f32 v[46:47], v[14:15], v[14:15], s[50:51]
  v_pk_fma_f32 v[32:33], v[0:1], v[32:33], s[52:53] neg_lo:[1,0,0] neg_hi:[1,0,0]
  v_pk_fma_f32 v[34:35], v[2:3], v[34:35], s[52:53] neg_lo:[1,0,0] neg_hi:[1,0,0]
  v_pk_fma_f32 v[36:37], v[4:5], v[36:37], s[52:53] neg_lo:[1,0,0] neg_hi:[1,0,0]
  v_pk_fma_f32 v[38:39], v[6:7], v[38:39], s[52:53] neg_lo:[1,0,0] neg_hi:[1,0,0]
  v_pk_fma_f32 v[40:41], v[8:9], v[40:41], s[52:53] neg_lo:[1,0,0] neg_hi:[1,0,0]
  v_pk_fma_f32 v[42:43], v[10:11], v[42:43], s[52:53] neg_lo:[1,0,0] neg_hi:[1,0,0]
  v_pk_fma_f32 v[44:45], v[12:13], v[44:45], s[52:53] neg_lo:[1,0,0] neg_hi:[1,0,0]
  v_pk_fma_f32 v[46:47], v[14:15], v[46:47], s[52:53] neg_lo:[1,0,0] neg_hi:[1,0,0]
  v_mfma_f32_32x32x16_bf16 v[16:31], v[136:139], v[112:115], 0
  v_exp_f32_e64 v32, v32 clamp
  v_exp_f32_e64 v33, v33 clamp
  v_exp_f32_e64 v34, v34 clamp
  v_mfma_f32_32x32x16_bf16 v[16:31], v[140:143], v[116:119], v[16:31]
  v_exp_f32_e64 v35, v35 clamp
  v_exp_f32_e64 v36, v36 clamp
  v_exp_f32_e64 v37, v37 clamp
  v_mfma_f32_32x32x16_bf16 v[16:31], v[144:147], v[120:123], v[16:31]
  v_exp_f32_e64 v38, v38 clamp
  v_exp_f32_e64 v39, v39 clamp
  v_exp_f32_e64 v40, v40 clamp
  v_mfma_f32_32x32x16_bf16 v[16:31], v[148:151], v[124:127], v[16:31]
  v_exp_f32_e64 v41, v41 clamp
  v_exp_f32_e64 v42, v42 clamp
  v_exp_f32_e64 v43, v43 clamp
  v_exp_f32_e64 v44, v44 clamp
  v_exp_f32_e64 v45, v45 clamp
  v_exp_f32_e64 v46, v46 clamp
  v_exp_f32_e64 v47, v47 clamp
  v_pk_add_f32 v[32:33], v[32:33], s[54:55]
  v_pk_add_f32 v[34:35], v[34:35], s[54:55]
  v_pk_add_f32 v[36:37], v[36:37], s[54:55]
  v_pk_add_f32 v[38:39], v[38:39], s[54:55]
  v_pk_add_f32 v[40:41], v[40:41], s[54:55]
  v_pk_add_f32 v[42:43], v[42:43], s[54:55]
  v_pk_add_f32 v[44:45], v[44:45], s[54:55]
  v_pk_add_f32 v[46:47], v[46:47], s[54:55]
  v_pk_mul_f32 v[0:1], v[0:1], v[34:35]
  v_pk_mul_f32 v[2:3], v[2:3], v[32:33]
  v_pk_mul_f32 v[4:5], v[4:5], v[38:39]
  v_pk_mul_f32 v[6:7], v[6:7], v[36:37]
  v_pk_mul_f32 v[8:9], v[8:9], v[42:43]
  v_pk_mul_f32 v[10:11], v[10:11], v[40:41]
  v_pk_mul_f32 v[12:13], v[12:13], v[46:47]
  v_pk_mul_f32 v[14:15], v[14:15], v[44:45]
  v_pk_mul_f32 v[32:33], v[32:33], v[34:35]
  v_pk_mul_f32 v[36:37], v[36:37], v[38:39]
  v_pk_mul_f32 v[40:41], v[40:41], v[42:43]
  v_pk_mul_f32 v[44:45], v[44:45], v[46:47]
  v_mfma_f32_32x32x16_bf16 v[16:31], v[152:155], v[128:131], v[16:31]
  v_rcp_f32_e32 v32, v32
  v_rcp_f32_e32 v33, v33
  v_rcp_f32_e32 v36, v36
  v_mfma_f32_32x32x16_bf16 v[16:31], v[156:159], v[132:135], v[16:31]
  v_rcp_f32_e32 v37, v37
  s_setprio 2
  s_waitcnt lgkmcnt(0)
  v_rcp_f32_e32 v40, v40
  v_rcp_f32_e32 v41, v41
  s_barrier
  ds_read_b128 v[136:139], v54 offset:0
  ds_read_b128 v[140:143], v54 offset:32
  ds_read_b128 v[144:147], v54 offset:64
  ds_read_b128 v[148:151], v54 offset:96
  ds_read_b128 v[152:155], v54 offset:128
  ds_read_b128 v[156:159], v54 offset:160
  v_rcp_f32_e32 v44, v44
  v_rcp_f32_e64 v45, v45
  v_pk_mul_f32 v[0:1], v[0:1], v[32:33]
  v_pk_mul_f32 v[2:3], v[2:3], v[32:33]
  v_pk_mul_f32 v[4:5], v[4:5], v[36:37]
  v_pk_mul_f32 v[6:7], v[6:7], v[36:37]
  v_pk_mul_f32 v[8:9], v[8:9], v[40:41]
  v_pk_mul_f32 v[10:11], v[10:11], v[40:41]
  v_pk_mul_f32 v[12:13], v[12:13], v[44:45]
  v_pk_mul_f32 v[14:15], v[14:15], v[44:45]
  v_pk_fma_f32 v[50:51], v[0:1], v[0:1], v[50:51]
  v_cvt_pk_bf16_f32 v32, v0, v1
  v_pk_fma_f32 v[50:51], v[2:3], v[2:3], v[50:51]
  v_cvt_pk_bf16_f32 v33, v2, v3
  v_pk_fma_f32 v[50:51], v[4:5], v[4:5], v[50:51]
  v_cvt_pk_bf16_f32 v34, v4, v5
  v_pk_fma_f32 v[50:51], v[6:7], v[6:7], v[50:51]
  v_cvt_pk_bf16_f32 v35, v6, v7
  v_pk_fma_f32 v[50:51], v[8:9], v[8:9], v[50:51]
  v_cvt_pk_bf16_f32 v36, v8, v9
  v_pk_fma_f32 v[50:51], v[10:11], v[10:11], v[50:51]
  v_cvt_pk_bf16_f32 v37, v10, v11
  v_pk_fma_f32 v[50:51], v[12:13], v[12:13], v[50:51]
  v_cvt_pk_bf16_f32 v38, v12, v13
  v_pk_fma_f32 v[50:51], v[14:15], v[14:15], v[50:51]
  v_cvt_pk_bf16_f32 v39, v14, v15
  ds_write_b128 v55, v[32:35] offset:26624
  ds_write_b128 v56, v[36:39] offset:26624
  s_waitcnt lgkmcnt(2)
  s_nop 0
  v_pk_fma_f32 v[32:33], v[16:17], v[16:17], s[50:51]
  v_pk_fma_f32 v[34:35], v[18:19], v[18:19], s[50:51]
  v_pk_fma_f32 v[36:37], v[20:21], v[20:21], s[50:51]
  v_pk_fma_f32 v[38:39], v[22:23], v[22:23], s[50:51]
  v_pk_fma_f32 v[40:41], v[24:25], v[24:25], s[50:51]
  v_pk_fma_f32 v[42:43], v[26:27], v[26:27], s[50:51]
  v_pk_fma_f32 v[44:45], v[28:29], v[28:29], s[50:51]
  v_pk_fma_f32 v[46:47], v[30:31], v[30:31], s[50:51]
  v_pk_fma_f32 v[32:33], v[16:17], v[32:33], s[52:53] neg_lo:[1,0,0] neg_hi:[1,0,0]
  v_pk_fma_f32 v[34:35], v[18:19], v[34:35], s[52:53] neg_lo:[1,0,0] neg_hi:[1,0,0]
  v_pk_fma_f32 v[36:37], v[20:21], v[36:37], s[52:53] neg_lo:[1,0,0] neg_hi:[1,0,0]
  v_pk_fma_f32 v[38:39], v[22:23], v[38:39], s[52:53] neg_lo:[1,0,0] neg_hi:[1,0,0]
  v_pk_fma_f32 v[40:41], v[24:25], v[40:41], s[52:53] neg_lo:[1,0,0] neg_hi:[1,0,0]
  v_pk_fma_f32 v[42:43], v[26:27], v[42:43], s[52:53] neg_lo:[1,0,0] neg_hi:[1,0,0]
  v_pk_fma_f32 v[44:45], v[28:29], v[44:45], s[52:53] neg_lo:[1,0,0] neg_hi:[1,0,0]
  v_pk_fma_f32 v[46:47], v[30:31], v[46:47], s[52:53] neg_lo:[1,0,0] neg_hi:[1,0,0]
  v_mfma_f32_32x32x16_bf16 v[0:15], v[136:139], v[64:67], 0
  v_exp_f32_e64 v32, v32 clamp
  v_exp_f32_e64 v33, v33 clamp
  v_exp_f32_e64 v34, v34 clamp
  v_mfma_f32_32x32x16_bf16 v[0:15], v[140:143], v[68:71], v[0:15]
  v_exp_f32_e64 v35, v35 clamp
  v_exp_f32_e64 v36, v36 clamp
  v_exp_f32_e64 v37, v37 clamp
  v_mfma_f32_32x32x16_bf16 v[0:15], v[144:147], v[72:75], v[0:15]
  v_exp_f32_e64 v38, v38 clamp
  v_exp_f32_e64 v39, v39 clamp
  v_exp_f32_e64 v40, v40 clamp
  v_mfma_f32_32x32x16_bf16 v[0:15], v[148:151], v[76:79], v[0:15]
  v_exp_f32_e64 v41, v41 clamp
  v_exp_f32_e64 v42, v42 clamp
  v_exp_f32_e64 v43, v43 clamp
  v_exp_f32_e64 v44, v44 clamp
  v_exp_f32_e64 v45, v45 clamp
  v_exp_f32_e64 v46, v46 clamp
  v_exp_f32_e64 v47, v47 clamp
  v_pk_add_f32 v[32:33], v[32:33], s[54:55]
  v_pk_add_f32 v[34:35], v[34:35], s[54:55]
  v_pk_add_f32 v[36:37], v[36:37], s[54:55]
  v_pk_add_f32 v[38:39], v[38:39], s[54:55]
  v_pk_add_f32 v[40:41], v[40:41], s[54:55]
  v_pk_add_f32 v[42:43], v[42:43], s[54:55]
  v_pk_add_f32 v[44:45], v[44:45], s[54:55]
  v_pk_add_f32 v[46:47], v[46:47], s[54:55]
  v_pk_mul_f32 v[16:17], v[16:17], v[34:35]
  v_pk_mul_f32 v[18:19], v[18:19], v[32:33]
  v_pk_mul_f32 v[20:21], v[20:21], v[38:39]
  v_pk_mul_f32 v[22:23], v[22:23], v[36:37]
  v_pk_mul_f32 v[24:25], v[24:25], v[42:43]
  v_pk_mul_f32 v[26:27], v[26:27], v[40:41]
  v_pk_mul_f32 v[28:29], v[28:29], v[46:47]
  v_pk_mul_f32 v[30:31], v[30:31], v[44:45]
  v_pk_mul_f32 v[32:33], v[32:33], v[34:35]
  v_pk_mul_f32 v[36:37], v[36:37], v[38:39]
  v_pk_mul_f32 v[40:41], v[40:41], v[42:43]
  v_pk_mul_f32 v[44:45], v[44:45], v[46:47]
  v_mfma_f32_32x32x16_bf16 v[0:15], v[152:155], v[80:83], v[0:15]
  v_rcp_f32_e32 v32, v32
  v_rcp_f32_e32 v33, v33
  v_rcp_f32_e32 v36, v36
  v_mfma_f32_32x32x16_bf16 v[0:15], v[156:159], v[84:87], v[0:15]
  v_rcp_f32_e32 v37, v37
  v_rcp_f32_e32 v40, v40
  v_rcp_f32_e32 v41, v41
  v_rcp_f32_e32 v44, v44
  v_rcp_f32_e32 v45, v45
  v_pk_mul_f32 v[16:17], v[16:17], v[32:33]
  v_pk_mul_f32 v[18:19], v[18:19], v[32:33]
  v_pk_mul_f32 v[20:21], v[20:21], v[36:37]
  v_pk_mul_f32 v[22:23], v[22:23], v[36:37]
  v_pk_mul_f32 v[24:25], v[24:25], v[40:41]
  v_pk_mul_f32 v[26:27], v[26:27], v[40:41]
  v_pk_mul_f32 v[28:29], v[28:29], v[44:45]
  v_pk_mul_f32 v[30:31], v[30:31], v[44:45]
  v_pk_fma_f32 v[52:53], v[16:17], v[16:17], v[52:53]
  v_cvt_pk_bf16_f32 v32, v16, v17
  v_pk_fma_f32 v[52:53], v[18:19], v[18:19], v[52:53]
  v_cvt_pk_bf16_f32 v33, v18, v19
  v_pk_fma_f32 v[52:53], v[20:21], v[20:21], v[52:53]
  v_cvt_pk_bf16_f32 v34, v20, v21
  v_pk_fma_f32 v[52:53], v[22:23], v[22:23], v[52:53]
  v_cvt_pk_bf16_f32 v35, v22, v23
  v_pk_fma_f32 v[52:53], v[24:25], v[24:25], v[52:53]
  v_cvt_pk_bf16_f32 v36, v24, v25
  v_pk_fma_f32 v[52:53], v[26:27], v[26:27], v[52:53]
  v_cvt_pk_bf16_f32 v37, v26, v27
  v_pk_fma_f32 v[52:53], v[28:29], v[28:29], v[52:53]
  v_cvt_pk_bf16_f32 v38, v28, v29
  v_pk_fma_f32 v[52:53], v[30:31], v[30:31], v[52:53]
  v_cvt_pk_bf16_f32 v39, v30, v31
  ds_write_b128 v55, v[32:35] offset:28672
  ds_write_b128 v56, v[36:39] offset:28672
  v_add_u32 v55, s59, v55
  v_add_u32 v56, s59, v56
  s_sub_u32 s59, s58, s59
  s_add_u32 s83, s83, 1
  s_cbranch_scc0 L_GLOOP0
  s_branch L_GWIN
L_GPRE1:
  s_add_u32 s100, s100, L_GOWN_RET1 - L_PC2
  s_addc_u32 s101, s101, 0
  .p2align 6
L_GLOOP1:
  v_pk_fma_f32 v[32:33], v[0:1], v[0:1], s[50:51]
  v_pk_fma_f32 v[34:35], v[2:3], v[2:3], s[50:51]
  v_pk_fma_f32 v[36:37], v[4:5], v[4:5], s[50:51]
  v_pk_fma_f32 v[38:39], v[6:7], v[6:7], s[50:51]
  v_pk_fma_f32 v[40:41], v[8:9], v[8:9], s[50:51]
  v_pk_fma_f32 v[42:43], v[10:11], v[10:11], s[50:51]
  v_pk_fma_f32 v[44:45], v[12:13], v[12:13], s[50:51]
  v_pk_fma_f32 v[46:47], v[14:15], v[14:15], s[50:51]
  v_pk_fma_f32 v[32:33], v[0:1], v[32:33], s[52:53] neg_lo:[1,0,0] neg_hi:[1,0,0]
  v_pk_fma_f32 v[34:35], v[2:3], v[34:35], s[52:53] neg_lo:[1,0,0] neg_hi:[1,0,0]
  v_pk_fma_f32 v[36:37], v[4:5], v[36:37], s[52:53] neg_lo:[1,0,0] neg_hi:[1,0,0]
  v_pk_fma_f32 v[38:39], v[6:7], v[38:39], s[52:53] neg_lo:[1,0,0] neg_hi:[1,0,0]
  v_pk_fma_f32 v[40:41], v[8:9], v[40:41], s[52:53] neg_lo:[1,0,0] neg_hi:[1,0,0]
  v_pk_fma_f32 v[42:43], v[10:11], v[42:43], s[52:53] neg_lo:[1,0,0] neg_hi:[1,0,0]
  v_pk_fma_f32 v[44:45], v[12:13], v[44:45], s[52:53] neg_lo:[1,0,0] neg_hi:[1,0,0]
  v_pk_fma_f32 v[46:47], v[14:15], v[46:47], s[52:53] neg_lo:[1,0,0] neg_hi:[1,0,0]
  v_mfma_f32_32x32x16_bf16 v[16:31], v[136:139], v[88:91], 0
  v_exp_f32_e64 v32, v32 clamp
  v_exp_f32_e64 v33, v33 clamp
  v_exp_f32_e64 v34, v34 clamp
  v_mfma_f32_32x32x16_bf16 v[16:31], v[140:143], v[92:95], v[16:31]
  v_exp_f32_e64 v35, v35 clamp
  v_exp_f32_e64 v36, v36 clamp
  v_exp_f32_e64 v37, v37 clamp
  v_mfma_f32_32x32x16_bf16 v[16:31], v[144:147], v[96:99], v[16:31]
  v_exp_f32_e64 v38, v38 clamp
  v_exp_f32_e64 v39, v39 clamp
  v_exp_f32_e64 v40, v40 clamp
  v_mfma_f32_32x32x16_bf16 v[16:31], v[148:151], v[100:103], v[16:31]
  v_exp_f32_e64 v41, v41 clamp
  v_exp_f32_e64 v42, v42 clamp
  v_exp_f32_e64 v43, v43 clamp
  v_exp_f32_e64 v44, v44 clamp
  v_exp_f32_e64 v45, v45 clamp
  v_exp_f32_e64 v46, v46 clamp
  v_exp_f32_e64 v47, v47 clamp
  v_pk_add_f32 v[32:33], v[32:33], s[54:55]
  v_pk_add_f32 v[34:35], v[34:35], s[54:55]
  v_pk_add_f32 v[36:37], v[36:37], s[54:55]
  v_pk_add_f32 v[38:39], v[38:39], s[54:55]
  v_pk_add_f32 v[40:41], v[40:41], s[54:55]
  v_pk_add_f32 v[42:43], v[42:43], s[54:55]
  v_pk_add_f32 v[44:45], v[44:45], s[54:55]
  v_pk_add_f32 v[46:47], v[46:47], s[54:55]
  v_pk_mul_f32 v[0:1], v[0:1], v[34:35]
  v_pk_mul_f32 v[2:3], v[2:3], v[32:33]
  v_pk_mul_f32 v[4:5], v[4:5], v[38:39]
  v_pk_mul_f32 v[6:7], v[6:7], v[36:37]
  v_pk_mul_f32 v[8:9], v[8:9], v[42:43]
  v_pk_mul_f32 v[10:11], v[10:11], v[40:41]
  v_pk_mul_f32 v[12:13], v[12:13], v[46:47]
  v_pk_mul_f32 v[14:15], v[14:15], v[44:45]
  v_pk_mul_f32 v[32:33], v[32:33], v[34:35]
  v_pk_mul_f32 v[36:37], v[36:37], v[38:39]
  v_pk_mul_f32 v[40:41], v[40:41], v[42:43]
  v_pk_mul_f32 v[44:45], v[44:45], v[46:47]
  v_mfma_f32_32x32x16_bf16 v[16:31], v[152:155], v[104:107], v[16:31]
  v_rcp_f32_e32 v32, v32
  v_rcp_f32_e32 v33, v33
  v_rcp_f32_e32 v36, v36
  v_mfma_f32_32x32x16_bf16 v[16:31], v[156:159], v[108:111], v[16:31]
  v_rcp_f32_e32 v37, v37
  v_rcp_f32_e32 v40, v40
  v_rcp_f32_e32 v41, v41
  v_rcp_f32_e32 v44, v44
  v_rcp_f32_e32 v45, v45
  v_pk_mul_f32 v[0:1], v[0:1], v[32:33]
  v_pk_mul_f32 v[2:3], v[2:3], v[32:33]
  v_pk_mul_f32 v[4:5], v[4:5], v[36:37]
  v_pk_mul_f32 v[6:7], v[6:7], v[36:37]
  v_pk_mul_f32 v[8:9], v[8:9], v[40:41]
  v_pk_mul_f32 v[10:11], v[10:11], v[40:41]
  v_pk_mul_f32 v[12:13], v[12:13], v[44:45]
  v_pk_mul_f32 v[14:15], v[14:15], v[44:45]
  v_pk_fma_f32 v[48:49], v[0:1], v[0:1], v[48:49]
  v_cvt_pk_bf16_f32 v32, v0, v1
  v_pk_fma_f32 v[48:49], v[2:3], v[2:3], v[48:49]
  v_cvt_pk_bf16_f32 v33, v2, v3
  v_pk_fma_f32 v[48:49], v[4:5], v[4:5], v[48:49]
  v_cvt_pk_bf16_f32 v34, v4, v5
  v_pk_fma_f32 v[48:49], v[6:7], v[6:7], v[48:49]
  v_cvt_pk_bf16_f32 v35, v6, v7
  v_pk_fma_f32 v[48:49], v[8:9], v[8:9], v[48:49]
  v_cvt_pk_bf16_f32 v36, v8, v9
  v_pk_fma_f32 v[48:49], v[10:11], v[10:11], v[48:49]
  v_cvt_pk_bf16_f32 v37, v10, v11
  v_pk_fma_f32 v[48:49], v[12:13], v[12:13], v[48:49]
  v_cvt_pk_bf16_f32 v38, v12, v13
  v_pk_fma_f32 v[48:49], v[14:15], v[14:15], v[48:49]
  v_cvt_pk_bf16_f32 v39, v14, v15
  s_setprio 0
  ds_write_b128 v55, v[32:35] offset:0
  ds_write_b128 v56, v[36:39] offset:0
  s_nop 0
  v_pk_fma_f32 v[32:33], v[16:17], v[16:17], s[50:51]
  v_pk_fma_f32 v[34:35], v[18:19], v[18:19], s[50:51]
  v_pk_fma_f32 v[36:37], v[20:21], v[20:21], s[50:51]
  v_pk_fma_f32 v[38:39], v[22:23], v[22:23], s[50:51]
  v_pk_fma_f32 v[40:41], v[24:25], v[24:25], s[50:51]
  v_pk_fma_f32 v[42:43], v[26:27], v[26:27], s[50:51]
  v_pk_fma_f32 v[44:45], v[28:29], v[28:29], s[50:51]
  v_pk_fma_f32 v[46:47], v[30:31], v[30:31], s[50:51]
  v_pk_fma_f32 v[32:33], v[16:17], v[32:33], s[52:53] neg_lo:[1,0,0] neg_hi:[1,0,0]
  v_pk_fma_f32 v[34:35], v[18:19], v[34:35], s[52:53] neg_lo:[1,0,0] neg_hi:[1,0,0]
  v_pk_fma_f32 v[36:37], v[20:21], v[36:37], s[52:53] neg_lo:[1,0,0] neg_hi:[1,0,0]
  v_pk_fma_f32 v[38:39], v[22:23], v[38:39], s[52:53] neg_lo:[1,0,0] neg_hi:[1,0,0]
  v_pk_fma_f32 v[40:41], v[24:25], v[40:41], s[52:53] neg_lo:[1,0,0] neg_hi:[1,0,0]
  v_pk_fma_f32 v[42:43], v[26:27], v[42:43], s[52:53] neg_lo:[1,0,0] neg_hi:[1,0,0]
  v_pk_fma_f32 v[44:45], v[28:29], v[44:45], s[52:53] neg_lo:[1,0,0] neg_hi:[1,0,0]
  v_pk_fma_f32 v[46:47], v[30:31], v[46:47], s[52:53] neg_lo:[1,0,0] neg_hi:[1,0,0]
  v_mfma_f32_32x32x16_bf16 v[0:15], v[136:139], v[112:115], 0
  v_exp_f32_e64 v32, v32 clamp
  v_exp_f32_e64 v33, v33 clamp
  v_exp_f32_e64 v34, v34 clamp
  v_mfma_f32_32x32x16_bf16 v[0:15], v[140:143], v[116:119], v[0:15]
  v_exp_f32_e64 v35, v35 clamp
  v_exp_f32_e64 v36, v36 clamp
  v_exp_f32_e64 v37, v37 clamp
  v_mfma_f32_32x32x16_bf16 v[0:15], v[144:147], v[120:123], v[0:15]
  v_exp_f32_e64 v38, v38 clamp
  v_exp_f32_e64 v39, v39 clamp
  s_setprio 2
  s_waitcnt lgkmcnt(0)
  v_exp_f32_e64 v40, v40 clamp
  v_mfma_f32_32x32x16_bf16 v[0:15], v[148:151], v[124:127], v[0:15]
  s_barrier
  v_exp_f32_e64 v41, v41 clamp
  v_exp_f32_e64 v42, v42 clamp
  v_exp_f32_e64 v43, v43 clamp
  v_exp_f32_e64 v44, v44 clamp
  v_exp_f32_e64 v45, v45 clamp
  v_exp_f32_e64 v46, v46 clamp
  v_exp_f32_e64 v47, v47 clamp
  s_nop 0
  v_pk_add_f32 v[32:33], v[32:33], s[54:55]
  v_pk_add_f32 v[34:35], v[34:35], s[54:55]
  v_pk_add_f32 v[36:37], v[36:37], s[54:55]
  v_pk_add_f32 v[38:39], v[38:39], s[54:55]
  v_pk_add_f32 v[40:41], v[40:41], s[54:55]
  v_pk_add_f32 v[42:43], v[42:43], s[54:55]
  v_pk_add_f32 v[44:45], v[44:45], s[54:55]
  v_pk_add_f32 v[46:47], v[46:47], s[54:55]
  v_pk_mul_f32 v[16:17], v[16:17], v[34:35]
  v_pk_mul_f32 v[18:19], v[18:19], v[32:33]
  v_pk_mul_f32 v[20:21], v[20:21], v[38:39]
  v_pk_mul_f32 v[22:23], v[22:23], v[36:37]
  v_pk_mul_f32 v[24:25], v[24:25], v[42:43]
  v_pk_mul_f32 v[26:27], v[26:27], v[40:41]
  v_pk_mul_f32 v[28:29], v[28:29], v[46:47]
  v_pk_mul_f32 v[30:31], v[30:31], v[44:45]
  v_pk_mul_f32 v[32:33], v[32:33], v[34:35]
  v_pk_mul_f32 v[36:37], v[36:37], v[38:39]
  v_pk_mul_f32 v[40:41], v[40:41], v[42:43]
  v_pk_mul_f32 v[44:45], v[44:45], v[46:47]
  v_mfma_f32_32x32x16_bf16 v[0:15], v[152:155], v[128:131], v[0:15]
  v_rcp_f32_e32 v32, v32
  v_rcp_f32_e32 v33, v33
  v_rcp_f32_e32 v36, v36
  v_mfma_f32_32x32x16_bf16 v[0:15], v[156:159], v[132:135], v[0:15]
  v_rcp_f32_e32 v37, v37
  v_rcp_f32_e32 v40, v40
  v_rcp_f32_e32 v41, v41
  ds_read_b128 v[136:139], v54 offset:6656
  ds_read_b128 v[140:143], v54 offset:6688
  ds_read_b128 v[144:147], v54 offset:6720
  ds_read_b128 v[148:151], v54 offset:6752
  ds_read_b128 v[152:155], v54 offset:6784
  ds_read_b128 v[156:159], v54 offset:6816
  v_rcp_f32_e32 v44, v44
  v_rcp_f32_e32 v45, v45
  v_pk_mul_f32 v[16:17], v[16:17], v[32:33]
  v_pk_mul_f32 v[18:19], v[18:19], v[32:33]
  v_pk_mul_f32 v[20:21], v[20:21], v[36:37]
  v_pk_mul_f32 v[22:23], v[22:23], v[36:37]
  v_pk_mul_f32 v[24:25], v[24:25], v[40:41]
  v_pk_mul_f32 v[26:27], v[26:27], v[40:41]
  v_pk_mul_f32 v[28:29], v[28:29], v[44:45]
  v_pk_mul_f32 v[30:31], v[30:31], v[44:45]
  v_pk_fma_f32 v[50:51], v[16:17], v[16:17], v[50:51]
  v_cvt_pk_bf16_f32 v32, v16, v17
  v_pk_fma_f32 v[50:51], v[18:19], v[18:19], v[50:51]
  v_cvt_pk_bf16_f32 v33, v18, v19
  v_pk_fma_f32 v[50:51], v[20:21], v[20:21], v[50:51]
  v_cvt_pk_bf16_f32 v34, v20, v21
  v_pk_fma_f32 v[50:51], v[22:23], v[22:23], v[50:51]
  v_cvt_pk_bf16_f32 v35, v22, v23
  v_pk_fma_f32 v[50:51], v[24:25], v[24:25], v[50:51]
  v_cvt_pk_bf16_f32 v36, v24, v25
  v_pk_fma_f32 v[50:51], v[26:27], v[26:27], v[50:51]
  v_cvt_pk_bf16_f32 v37, v26, v27
  v_pk_fma_f32 v[50:51], v[28:29], v[28:29], v[50:51]
  v_cvt_pk_bf16_f32 v38, v28, v29
  v_pk_fma_f32 v[50:51], v[30:31], v[30:31], v[50:51]
  v_cvt_pk_bf16_f32 v39, v30, v31
  ds_write_b128 v55, v[32:35] offset:2048
  ds_write_b128 v56, v[36:39] offset:2048
  s_waitcnt lgkmcnt(2)
  s_nop 0
  v_pk_fma_f32 v[32:33], v[0:1], v[0:1], s[50:51]
  v_pk_fma_f32 v[34:35], v[2:3], v[2:3], s[50:51]
  v_pk_fma_f32 v[36:37], v[4:5], v[4:5], s[50:51]
  v_pk_fma_f32 v[38:39], v[6:7], v[6:7], s[50:51]
  v_pk_fma_f32 v[40:41], v[8:9], v[8:9], s[50:51]
  v_pk_fma_f32 v[42:43], v[10:11], v[10:11], s[50:51]
  v_pk_fma_f32 v[44:45], v[12:13], v[12:13], s[50:51]
  v_pk_fma_f32 v[46:47], v[14:15], v[14:15], s[50:51]
  v_pk_fma_f32 v[32:33], v[0:1], v[32:33], s[52:53] neg_lo:[1,0,0] neg_hi:[1,0,0]
  v_pk_fma_f32 v[34:35], v[2:3], v[34:35], s[52:53] neg_lo:[1,0,0] neg_hi:[1,0,0]
  v_pk_fma_f32 v[36:37], v[4:5], v[36:37], s[52:53] neg_lo:[1,0,0] neg_hi:[1,0,0]
  v_pk_fma_f32 v[38:39], v[6:7], v[38:39], s[52:53] neg_lo:[1,0,0] neg_hi:[1,0,0]
  v_pk_fma_f32 v[40:41], v[8:9], v[40:41], s[52:53] neg_lo:[1,0,0] neg_hi:[1,0,0]
  v_pk_fma_f32 v[42:43], v[10:11], v[42:43], s[52:53] neg_lo:[1,0,0] neg_hi:[1,0,0]
  v_pk_fma_f32 v[44:45], v[12:13], v[44:45], s[52:53] neg_lo:[1,0,0] neg_hi:[1,0,0]
  v_pk_fma_f32 v[46:47], v[14:15], v[46:47], s[52:53] neg_lo:[1,0,0] neg_hi:[1,0,0]
  v_mfma_f32_32x32x16_bf16 v[16:31], v[136:139], v[64:67], 0
  v_exp_f32_e64 v32, v32 clamp
  v_exp_f32_e64 v33, v33 clamp
  v_exp_f32_e64 v34, v34 clamp
  v_mfma_f32_32x32x16_bf16 v[16:31], v[140:143], v[68:71], v[16:31]
  v_exp_f32_e64 v35, v35 clamp
  v_exp_f32_e64 v36, v36 clamp
  v_exp_f32_e64 v37, v37 clamp
  v_mfma_f32_32x32x16_bf16 v[16:31], v[144:147], v[72:75], v[16:31]
  v_exp_f32_e64 v38, v38 clamp
  v_exp_f32_e64 v39, v39 clamp
  v_exp_f32_e64 v40, v40 clamp
  v_mfma_f32_32x32x16_bf16 v[16:31], v[148:151], v[76:79], v[16:31]
  v_exp_f32_e64 v41, v41 clamp
  v_exp_f32_e64 v42, v42 clamp
  v_exp_f32_e64 v43, v43 clamp
  v_exp_f32_e64 v44, v44 clamp
  v_exp_f32_e64 v45, v45 clamp
  v_exp_f32_e64 v46, v46 clamp
  v_exp_f32_e64 v47, v47 clamp
  v_pk_add_f32 v[32:33], v[32:33], s[54:55]
  v_pk_add_f32 v[34:35], v[34:35], s[54:55]
  v_pk_add_f32 v[36:37], v[36:37], s[54:55]
  v_pk_add_f32 v[38:39], v[38:39], s[54:55]
  v_pk_add_f32 v[40:41], v[40:41], s[54:55]
  v_pk_add_f32 v[42:43], v[42:43], s[54:55]
  v_pk_add_f32 v[44:45], v[44:45], s[54:55]
  v_pk_add_f32 v[46:47], v[46:47], s[54:55]
  v_pk_mul_f32 v[0:1], v[0:1], v[34:35]
  v_pk_mul_f32 v[2:3], v[2:3], v[32:33]
  v_pk_mul_f32 v[4:5], v[4:5], v[38:39]
  v_pk_mul_f32 v[6:7], v[6:7], v[36:37]
  v_pk_mul_f32 v[8:9], v[8:9], v[42:43]
  v_pk_mul_f32 v[10:11], v[10:11], v[40:41]
  v_pk_mul_f32 v[12:13], v[12:13], v[46:47]
  v_pk_mul_f32 v[14:15], v[14:15], v[44:45]
  v_pk_mul_f32 v[32:33], v[32:33], v[34:35]
  v_pk_mul_f32 v[36:37], v[36:37], v[38:39]
  v_pk_mul_f32 v[40:41], v[40:41], v[42:43]
  v_pk_mul_f32 v[44:45], v[44:45], v[46:47]
  v_mfma_f32_32x32x16_bf16 v[16:31], v[152:155], v[80:83], v[16:31]
  v_rcp_f32_e32 v32, v32
  v_rcp_f32_e32 v33, v33
  v_rcp_f32_e32 v36, v36
  v_mfma_f32_32x32x16_bf16 v[16:31], v[156:159], v[84:87], v[16:31]
  v_rcp_f32_e32 v37, v37
  v_rcp_f32_e32 v40, v40
  v_rcp_f32_e32 v41, v41
  v_rcp_f32_e32 v44, v44
  v_rcp_f32_e32 v45, v45
  v_pk_mul_f32 v[0:1], v[0:1], v[32:33]
  v_pk_mul_f32 v[2:3], v[2:3], v[32:33]
  v_pk_mul_f32 v[4:5], v[4:5], v[36:37]
  v_pk_mul_f32 v[6:7], v[6:7], v[36:37]
  v_pk_mul_f32 v[8:9], v[8:9], v[40:41]
  v_pk_mul_f32 v[10:11], v[10:11], v[40:41]
  v_pk_mul_f32 v[12:13], v[12:13], v[44:45]
  v_pk_mul_f32 v[14:15], v[14:15], v[44:45]
  v_pk_fma_f32 v[52:53], v[0:1], v[0:1], v[52:53]
  v_cvt_pk_bf16_f32 v32, v0, v1
  v_pk_fma_f32 v[52:53], v[2:3], v[2:3], v[52:53]
  v_cvt_pk_bf16_f32 v33, v2, v3
  v_pk_fma_f32 v[52:53], v[4:5], v[4:5], v[52:53]
  v_cvt_pk_bf16_f32 v34, v4, v5
  v_pk_fma_f32 v[52:53], v[6:7], v[6:7], v[52:53]
  v_cvt_pk_bf16_f32 v35, v6, v7
  v_pk_fma_f32 v[52:53], v[8:9], v[8:9], v[52:53]
  v_cvt_pk_bf16_f32 v36, v8, v9
  v_pk_fma_f32 v[52:53], v[10:11], v[10:11], v[52:53]
  v_cvt_pk_bf16_f32 v37, v10, v11
  v_pk_fma_f32 v[52:53], v[12:13], v[12:13], v[52:53]
  v_cvt_pk_bf16_f32 v38, v12, v13
  v_pk_fma_f32 v[52:53], v[14:15], v[14:15], v[52:53]
  v_cvt_pk_bf16_f32 v39, v14, v15
  ds_write_b128 v55, v[32:35] offset:4096
  ds_write_b128 v56, v[36:39] offset:4096
  s_bitcmp1_b32 s82, s83
  s_cbranch_scc1 L_GOWN
L_GOWN_RET1:
  v_pk_fma_f32 v[32:33], v[16:17], v[16:17], s[50:51]
  v_pk_fma_f32 v[34:35], v[18:19], v[18:19], s[50:51]
  v_pk_fma_f32 v[36:37], v[20:21], v[20:21], s[50:51]
  v_pk_fma_f32 v[38:39], v[22:23], v[22:23], s[50:51]
  v_pk_fma_f32 v[40:41], v[24:25], v[24:25], s[50:51]
  v_pk_fma_f32 v[42:43], v[26:27], v[26:27], s[50:51]
  v_pk_fma_f32 v[44:45], v[28:29], v[28:29], s[50:51]
  v_pk_fma_f32 v[46:47], v[30:31], v[30:31], s[50:51]
  v_pk_fma_f32 v[32:33], v[16:17], v[32:33], s[52:53] neg_lo:[1,0,0] neg_hi:[1,0,0]
  v_pk_fma_f32 v[34:35], v[18:19], v[34:35], s[52:53] neg_lo:[1,0,0] neg_hi:[1,0,0]
  v_pk_fma_f32 v[36:37], v[20:21], v[36:37], s[52:53] neg_lo:[1,0,0] neg_hi:[1,0,0]
  v_pk_fma_f32 v[38:39], v[22:23], v[38:39], s[52:53] neg_lo:[1,0,0] neg_hi:[1,0,0]
  v_pk_fma_f32 v[40:41], v[24:25], v[40:41], s[52:53] neg_lo:[1,0,0] neg_hi:[1,0,0]
  v_pk_fma_f32 v[42:43], v[26:27], v[42:43], s[52:53] neg_lo:[1,0,0] neg_hi:[1,0,0]
  v_pk_fma_f32 v[44:45], v[28:29], v[44:45], s[52:53] neg_lo:[1,0,0] neg_hi:[1,0,0]
  v_pk_fma_f32 v[46:47], v[30:31], v[46:47], s[52:53] neg_lo:[1,0,0] neg_hi:[1,0,0]
  v_mfma_f32_32x32x16_bf16 v[0:15], v[136:139], v[88:91], 0
  v_exp_f32_e64 v32, v32 clamp
  v_exp_f32_e64 v33, v33 clamp
  v_exp_f32_e64 v34, v34 clamp
  v_mfma_f32_32x32x16_bf16 v[0:15], v[140:143], v[92:95], v[0:15]
  v_exp_f32_e64 v35, v35 clamp
  v_exp_f32_e64 v36, v36 clamp
  v_exp_f32_e64 v37, v37 clamp
  v_mfma_f32_32x32x16_bf16 v[0:15], v[144:147], v[96:99], v[0:15]
  v_exp_f32_e64 v38, v38 clamp
  v_exp_f32_e64 v39, v39 clamp
  v_exp_f32_e64 v40, v40 clamp
  v_mfma_f32_32x32x16_bf16 v[0:15], v[148:151], v[100:103], v[0:15]
  v_exp_f32_e64 v41, v41 clamp
  v_exp_f32_e64 v42, v42 clamp
  v_exp_f32_e64 v43, v43 clamp
  v_exp_f32_e64 v44, v44 clamp
  v_exp_f32_e64 v45, v45 clamp
  v_exp_f32_e64 v46, v46 clamp
  v_exp_f32_e64 v47, v47 clamp
  v_pk_add_f32 v[32:33], v[32:33], s[54:55]
  v_pk_add_f32 v[34:35], v[34:35], s[54:55]
  v_pk_add_f32 v[36:37], v[36:37], s[54:55]
  v_pk_add_f32 v[38:39], v[38:39], s[54:55]
  v_pk_add_f32 v[40:41], v[40:41], s[54:55]
  v_pk_add_f32 v[42:43], v[42:43], s[54:55]
  v_pk_add_f32 v[44:45], v[44:45], s[54:55]
  v_pk_add_f32 v[46:47], v[46:47], s[54:55]
  v_pk_mul_f32 v[16:17], v[16:17], v[34:35]
  v_pk_mul_f32 v[18:19], v[18:19], v[32:33]
  v_pk_mul_f32 v[20:21], v[20:21], v[38:39]
  v_pk_mul_f32 v[22:23], v[22:23], v[36:37]
  v_pk_mul_f32 v[24:25], v[24:25], v[42:43]
  v_pk_mul_f32 v[26:27], v[26:27], v[40:41]
  v_pk_mul_f32 v[28:29], v[28:29], v[46:47]
  v_pk_mul_f32 v[30:31], v[30:31], v[44:45]
  v_pk_mul_f32 v[32:33], v[32:33], v[34:35]
  v_pk_mul_f32 v[36:37], v[36:37], v[38:39]
  v_pk_mul_f32 v[40:41], v[40:41], v[42:43]
  v_pk_mul_f32 v[44:45], v[44:45], v[46:47]
  v_mfma_f32_32x32x16_bf16 v[0:15], v[152:155], v[104:107], v[0:15]
  v_rcp_f32_e32 v32, v32
  v_rcp_f32_e32 v33, v33
  v_rcp_f32_e32 v36, v36
  v_mfma_f32_32x32x16_bf16 v[0:15], v[156:159], v[108:111], v[0:15]
  v_rcp_f32_e32 v37, v37
  v_rcp_f32_e32 v40, v40
  v_rcp_f32_e32 v41, v41
  v_rcp_f32_e32 v44, v44
  v_rcp_f32_e32 v45, v45
  v_pk_mul_f32 v[16:17], v[16:17], v[32:33]
  v_pk_mul_f32 v[18:19], v[18:19], v[32:33]
  v_pk_mul_f32 v[20:21], v[20:21], v[36:37]
  v_pk_mul_f32 v[22:23], v[22:23], v[36:37]
  v_pk_mul_f32 v[24:25], v[24:25], v[40:41]
  v_pk_mul_f32 v[26:27], v[26:27], v[40:41]
  v_pk_mul_f32 v[28:29], v[28:29], v[44:45]
  v_pk_mul_f32 v[30:31], v[30:31], v[44:45]
  v_pk_fma_f32 v[48:49], v[16:17], v[16:17], v[48:49]
  v_cvt_pk_bf16_f32 v32, v16, v17
  v_pk_fma_f32 v[48:49], v[18:19], v[18:19], v[48:49]
  v_cvt_pk_bf16_f32 v33, v18, v19
  v_pk_fma_f32 v[48:49], v[20:21], v[20:21], v[48:49]
  v_cvt_pk_bf16_f32 v34, v20, v21
  v_pk_fma_f32 v[48:49], v[22:23], v[22:23], v[48:49]
  v_cvt_pk_bf16_f32 v35, v22, v23
  v_pk_fma_f32 v[48:49], v[24:25], v[24:25], v[48:49]
  v_cvt_pk_bf16_f32 v36, v24, v25
  v_pk_fma_f32 v[48:49], v[26:27], v[26:27], v[48:49]
  v_cvt_pk_bf16_f32 v37, v26, v27
  v_pk_fma_f32 v[48:49], v[28:29], v[28:29], v[48:49]
  v_cvt_pk_bf16_f32 v38, v28, v29
  v_pk_fma_f32 v[48:49], v[30:31], v[30:31], v[48:49]
  v_cvt_pk_bf16_f32 v39, v30, v31
  s_setprio 0
  ds_write_b128 v55, v[32:35] offset:24576
  ds_write_b128 v56, v[36:39] offset:24576
  s_nop 0
  v_pk_fma_f32 v[32:33], v[0:1], v[0:1], s[50:51]
  v_pk_fma_f32 v[34:35], v[2:3], v[2:3], s[50:51]
  v_pk_fma_f32 v[36:37], v[4:5], v[4:5], s[50:51]
  v_pk_fma_f32 v[38:39], v[6:7], v[6:7], s[50:51]
  v_pk_fma_f32 v[40:41], v[8:9], v[8:9], s[50:51]
  v_pk_fma_f32 v[42:43], v[10:11], v[10:11], s[50:51]
  v_pk_fma_f32 v[44:45], v[12:13], v[12:13], s[50:51]
  v_pk_fma_f32 v[46:47], v[14:15], v[14:15], s[50:51]
  v_pk_fma_f32 v[32:33], v[0:1], v[32:33], s[52:53] neg_lo:[1,0,0] neg_hi:[1,0,0]
  v_pk_fma_f32 v[34:35], v[2:3], v[34:35], s[52:53] neg_lo:[1,0,0] neg_hi:[1,0,0]
  v_pk_fma_f32 v[36:37], v[4:5], v[36:37], s[52:53] neg_lo:[1,0,0] neg_hi:[1,0,0]
  v_pk_fma_f32 v[38:39], v[6:7], v[38:39], s[52:53] neg_lo:[1,0,0] neg_hi:[1,0,0]
  v_pk_fma_f32 v[40:41], v[8:9], v[40:41], s[52:53] neg_lo:[1,0,0] neg_hi:[1,0,0]
  v_pk_fma_f32 v[42:43], v[10:11], v[42:43], s[52:53] neg_lo:[1,0,0] neg_hi:[1,0,0]
  v_pk_fma_f32 v[44:45], v[12:13], v[44:45], s[52:53] neg_lo:[1,0,0] neg_hi:[1,0,0]
  v_pk_fma_f32 v[46:47], v[14:15], v[46:47], s[52:53] neg_lo:[1,0,0] neg_hi:[1,0,0]
  v_mfma_f32_32x32x16_bf16 v[16:31], v[136:139], v[112:115], 0
  v_exp_f32_e64 v32, v32 clamp
  v_exp_f32_e64 v33, v33 clamp
  v_exp_f32_e64 v34, v34 clamp
  v_mfma_f32_32x32x16_bf16 v[16:31], v[140:143], v[116:119], v[16:31]
  v_exp_f32_e64 v35, v35 clamp
  v_exp_f32_e64 v36, v36 clamp
  v_exp_f32_e64 v37, v37 clamp
  v_mfma_f32_32x32x16_bf16 v[16:31], v[144:147], v[120:123], v[16:31]
  v_exp_f32_e64 v38, v38 clamp
  v_exp_f32_e64 v39, v39 clamp
  s_setprio 2
  s_waitcnt lgkmcnt(0)
  v_exp_f32_e64 v40, v40 clamp
  v_mfma_f32_32x32x16_bf16 v[16:31], v[148:151], v[124:127], v[16:31]
  s_barrier
  v_exp_f32_e64 v41, v41 clamp
  v_exp_f32_e64 v42, v42 clamp
  v_exp_f32_e64 v43, v43 clamp
  v_exp_f32_e64 v44, v44 clamp
  v_exp_f32_e64 v45, v45 clamp
  v_exp_f32_e64 v46, v46 clamp
  v_exp_f32_e64 v47, v47 clamp
  s_nop 0
  v_pk_add_f32 v[32:33], v[32:33], s[54:55]
  v_pk_add_f32 v[34:35], v[34:35], s[54:55]
  v_pk_add_f32 v[36:37], v[36:37], s[54:55]
  v_pk_add_f32 v[38:39], v[38:39], s[54:55]
  v_pk_add_f32 v[40:41], v[40:41], s[54:55]
  v_pk_add_f32 v[42:43], v[42:43], s[54:55]
  v_pk_add_f32 v[44:45], v[44:45], s[54:55]
  v_pk_add_f32 v[46:47], v[46:47], s[54:55]
  v_pk_mul_f32 v[0:1], v[0:1], v[34:35]
  v_pk_mul_f32 v[2:3], v[2:3], v[32:33]
  v_pk_mul_f32 v[4:5], v[4:5], v[38:39]
  v_pk_mul_f32 v[6:7], v[6:7], v[36:37]
  v_pk_mul_f32 v[8:9], v[8:9], v[42:43]
  v_pk_mul_f32 v[10:11], v[10:11], v[40:41]
  v_pk_mul_f32 v[12:13], v[12:13], v[46:47]
  v_pk_mul_f32 v[14:15], v[14:15], v[44:45]
  v_pk_mul_f32 v[32:33], v[32:33], v[34:35]
  v_pk_mul_f32 v[36:37], v[36:37], v[38:39]
  v_pk_mul_f32 v[40:41], v[40:41], v[42:43]
  v_pk_mul_f32 v[44:45], v[44:45], v[46:47]
  v_mfma_f32_32x32x16_bf16 v[16:31], v[152:155], v[128:131], v[16:31]
  v_rcp_f32_e32 v32, v32
  v_rcp_f32_e32 v33, v33
  v_rcp_f32_e32 v36, v36
  v_mfma_f32_32x32x16_bf16 v[16:31], v[156:159], v[132:135], v[16:31]
  v_rcp_f32_e32 v37, v37
  v_rcp_f32_e32 v40, v40
  v_rcp_f32_e32 v41, v41
  ds_read_b128 v[136:139], v54 offset:0
  ds_read_b128 v[140:143], v54 offset:32
  ds_read_b128 v[144:147], v54 offset:64
  ds_read_b128 v[148:151], v54 offset:96
  ds_read_b128 v[152:155], v54 offset:128
  ds_read_b128 v[156:159], v54 offset:160
  v_rcp_f32_e32 v44, v44
  v_rcp_f32_e32 v45, v45
  v_pk_mul_f32 v[0:1], v[0:1], v[32:33]
  v_pk_mul_f32 v[2:3], v[2:3], v[32:33]
  v_pk_mul_f32 v[4:5], v[4:5], v[36:37]
  v_pk_mul_f32 v[6:7], v[6:7], v[36:37]
  v_pk_mul_f32 v[8:9], v[8:9], v[40:41]
  v_pk_mul_f32 v[10:11], v[10:11], v[40:41]
  v_pk_mul_f32 v[12:13], v[12:13], v[44:45]
  v_pk_mul_f32 v[14:15], v[14:15], v[44:45]
  v_pk_fma_f32 v[50:51], v[0:1], v[0:1], v[50:51]
  v_cvt_pk_bf16_f32 v32, v0, v1
  v_pk_fma_f32 v[50:51], v[2:3], v[2:3], v[50:51]
  v_cvt_pk_bf16_f32 v33, v2, v3
  v_pk_fma_f32 v[50:51], v[4:5], v[4:5], v[50:51]
  v_cvt_pk_bf16_f32 v34, v4, v5
  v_pk_fma_f32 v[50:51], v[6:7], v[6:7], v[50:51]
  v_cvt_pk_bf16_f32 v35, v6, v7
  v_pk_fma_f32 v[50:51], v[8:9], v[8:9], v[50:51]
  v_cvt_pk_bf16_f32 v36, v8, v9
  v_pk_fma_f32 v[50:51], v[10:11], v[10:11], v[50:51]
  v_cvt_pk_bf16_f32 v37, v10, v11
  v_pk_fma_f32 v[50:51], v[12:13], v[12:13], v[50:51]
  v_cvt_pk_bf16_f32 v38, v12, v13
  v_pk_fma_f32 v[50:51], v[14:15], v[14:15], v[50:51]
  v_cvt_pk_bf16_f32 v39, v14, v15
  ds_write_b128 v55, v[32:35] offset:26624
  ds_write_b128 v56, v[36:39] offset:26624
  s_waitcnt lgkmcnt(2)
  s_nop 0
  v_pk_fma_f32 v[32:33], v[16:17], v[16:17], s[50:51]
  v_pk_fma_f32 v[34:35], v[18:19], v[18:19], s[50:51]
  v_pk_fma_f32 v[36:37], v[20:21], v[20:21], s[50:51]
  v_pk_fma_f32 v[38:39], v[22:23], v[22:23], s[50:51]
  v_pk_fma_f32 v[40:41], v[24:25], v[24:25], s[50:51]
  v_pk_fma_f32 v[42:43], v[26:27], v[26:27], s[50:51]
  v_pk_fma_f32 v[44:45], v[28:29], v[28:29], s[50:51]
  v_pk_fma_f32 v[46:47], v[30:31], v[30:31], s[50:51]
  v_pk_fma_f32 v[32:33], v[16:17], v[32:33], s[52:53] neg_lo:[1,0,0] neg_hi:[1,0,0]
  v_pk_fma_f32 v[34:35], v[18:19], v[34:35], s[52:53] neg_lo:[1,0,0] neg_hi:[1,0,0]
  v_pk_fma_f32 v[36:37], v[20:21], v[36:37], s[52:53] neg_lo:[1,0,0] neg_hi:[1,0,0]
  v_pk_fma_f32 v[38:39], v[22:23], v[38:39], s[52:53] neg_lo:[1,0,0] neg_hi:[1,0,0]
  v_pk_fma_f32 v[40:41], v[24:25], v[40:41], s[52:53] neg_lo:[1,0,0] neg_hi:[1,0,0]
  v_pk_fma_f32 v[42:43], v[26:27], v[42:43], s[52:53] neg_lo:[1,0,0] neg_hi:[1,0,0]
  v_pk_fma_f32 v[44:45], v[28:29], v[44:45], s[52:53] neg_lo:[1,0,0] neg_hi:[1,0,0]
  v_pk_fma_f32 v[46:47], v[30:31], v[46:47], s[52:53] neg_lo:[1,0,0] neg_hi:[1,0,0]
  v_mfma_f32_32x32x16_bf16 v[0:15], v[136:139], v[64:67], 0
  v_exp_f32_e64 v32, v32 clamp
  v_exp_f32_e64 v33, v33 clamp
  v_exp_f32_e64 v34, v34 clamp
  v_mfma_f32_32x32x16_bf16 v[0:15], v[140:143], v[68:71], v[0:15]
  v_exp_f32_e64 v35, v35 clamp
  v_exp_f32_e64 v36, v36 clamp
  v_exp_f32_e64 v37, v37 clamp
  v_mfma_f32_32x32x16_bf16 v[0:15], v[144:147], v[72:75], v[0:15]
  v_exp_f32_e64 v38, v38 clamp
  v_exp_f32_e64 v39, v39 clamp
  v_exp_f32_e64 v40, v40 clamp
  v_mfma_f32_32x32x16_bf16 v[0:15], v[148:151], v[76:79], v[0:15]
  v_exp_f32_e64 v41, v41 clamp
  v_exp_f32_e64 v42, v42 clamp
  v_exp_f32_e64 v43, v43 clamp
  v_exp_f32_e64 v44, v44 clamp
  v_exp_f32_e64 v45, v45 clamp
  v_exp_f32_e64 v46, v46 clamp
  v_exp_f32_e64 v47, v47 clamp
  v_pk_add_f32 v[32:33], v[32:33], s[54:55]
  v_pk_add_f32 v[34:35], v[34:35], s[54:55]
  v_pk_add_f32 v[36:37], v[36:37], s[54:55]
  v_pk_add_f32 v[38:39], v[38:39], s[54:55]
  v_pk_add_f32 v[40:41], v[40:41], s[54:55]
  v_pk_add_f32 v[42:43], v[42:43], s[54:55]
  v_pk_add_f32 v[44:45], v[44:45], s[54:55]
  v_pk_add_f32 v[46:47], v[46:47], s[54:55]
  v_pk_mul_f32 v[16:17], v[16:17], v[34:35]
  v_pk_mul_f32 v[18:19], v[18:19], v[32:33]
  v_pk_mul_f32 v[20:21], v[20:21], v[38:39]
  v_pk_mul_f32 v[22:23], v[22:23], v[36:37]
  v_pk_mul_f32 v[24:25], v[24:25], v[42:43]
  v_pk_mul_f32 v[26:27], v[26:27], v[40:41]
  v_pk_mul_f32 v[28:29], v[28:29], v[46:47]
  v_pk_mul_f32 v[30:31], v[30:31], v[44:45]
  v_pk_mul_f32 v[32:33], v[32:33], v[34:35]
  v_pk_mul_f32 v[36:37], v[36:37], v[38:39]
  v_pk_mul_f32 v[40:41], v[40:41], v[42:43]
  v_pk_mul_f32 v[44:45], v[44:45], v[46:47]
  v_mfma_f32_32x32x16_bf16 v[0:15], v[152:155], v[80:83], v[0:15]
  v_rcp_f32_e32 v32, v32
  v_rcp_f32_e32 v33, v33
  v_rcp_f32_e32 v36, v36
  v_mfma_f32_32x32x16_bf16 v[0:15], v[156:159], v[84:87], v[0:15]
  v_rcp_f32_e32 v37, v37
  v_rcp_f32_e32 v40, v40
  v_rcp_f32_e32 v41, v41
  v_rcp_f32_e32 v44, v44
  v_rcp_f32_e32 v45, v45
  v_pk_mul_f32 v[16:17], v[16:17], v[32:33]
  v_pk_mul_f32 v[18:19], v[18:19], v[32:33]
  v_pk_mul_f32 v[20:21], v[20:21], v[36:37]
  v_pk_mul_f32 v[22:23], v[22:23], v[36:37]
  v_pk_mul_f32 v[24:25], v[24:25], v[40:41]
  v_pk_mul_f32 v[26:27], v[26:27], v[40:41]
  v_pk_mul_f32 v[28:29], v[28:29], v[44:45]
  v_pk_mul_f32 v[30:31], v[30:31], v[44:45]
  v_pk_fma_f32 v[52:53], v[16:17], v[16:17], v[52:53]
  v_cvt_pk_bf16_f32 v32, v16, v17
  v_pk_fma_f32 v[52:53], v[18:19], v[18:19], v[52:53]
  v_cvt_pk_bf16_f32 v33, v18, v19
  v_pk_fma_f32 v[52:53], v[20:21], v[20:21], v[52:53]
  v_cvt_pk_bf16_f32 v34, v20, v21
  v_pk_fma_f32 v[52:53], v[22:23], v[22:23], v[52:53]
  v_cvt_pk_bf16_f32 v35, v22, v23
  v_pk_fma_f32 v[52:53], v[24:25], v[24:25], v[52:53]
  v_cvt_pk_bf16_f32 v36, v24, v25
  v_pk_fma_f32 v[52:53], v[26:27], v[26:27], v[52:53]
  v_cvt_pk_bf16_f32 v37, v26, v27
  v_pk_fma_f32 v[52:53], v[28:29], v[28:29], v[52:53]
  v_cvt_pk_bf16_f32 v38, v28, v29
  v_pk_fma_f32 v[52:53], v[30:31], v[30:31], v[52:53]
  v_cvt_pk_bf16_f32 v39, v30, v31
  ds_write_b128 v55, v[32:35] offset:28672
  ds_write_b128 v56, v[36:39] offset:28672
  v_add_u32 v55, s59, v55
  v_add_u32 v56, s59, v56
  s_sub_u32 s59, s58, s59
  s_add_u32 s83, s83, 1
  s_cbranch_scc0 L_GLOOP1
L_GWIN:
  v_add_f32 v4, v48, v49
  v_add_f32 v5, v50, v51
  v_add_f32 v6, v52, v53
  v_mov_b32 v7, v6
  s_nop 1
  v_permlane32_swap_b32 v4, v5
  v_permlane32_swap_b32 v6, v7
  s_nop 0
  v_add_f32 v4, v4, v5
  v_add_f32 v6, v6, v7
  v_and_b32 v4, 0x7fffffff, v4
  v_and_b32 v6, 0x7fffffff, v6
  buffer_store_dword v4, v60, s[12:15], s86 offen sc1
  buffer_store_dword v6, v61, s[12:15], s87 offen sc1
  s_setprio 0
  v_mbcnt_lo_u32_b32 v2, -1, 0
  v_mbcnt_hi_u32_b32 v2, -1, v2
  v_mul_u32_u24 v152, 12, v2
  s_lshr_b32 s45, s41, 1
  s_mul_i32 s45, s45, 18432
  s_sub_u32 s45, s45, 49152
  v_subrev_u32 v8, s45, v57
  v_subrev_u32 v9, s45, v58
  ds_read_b64_tr_b16 v[64:65], v8 offset:0
  ds_read_b64_tr_b16 v[66:67], v9 offset:0
  ds_read_b64_tr_b16 v[68:69], v8 offset:2048
  ds_read_b64_tr_b16 v[70:71], v9 offset:2048
  ds_read_b64_tr_b16 v[72:73], v8 offset:4096
  ds_read_b64_tr_b16 v[74:75], v9 offset:4096
  ds_read_b64_tr_b16 v[76:77], v8 offset:12288
  ds_read_b64_tr_b16 v[78:79], v9 offset:12288
  ds_read_b64_tr_b16 v[80:81], v8 offset:14336
  ds_read_b64_tr_b16 v[82:83], v9 offset:14336
  ds_read_b64_tr_b16 v[84:85], v8 offset:16384
  ds_read_b64_tr_b16 v[86:87], v9 offset:16384
  ds_read_b64_tr_b16 v[88:89], v8 offset:24576
  ds_read_b64_tr_b16 v[90:91], v9 offset:24576
  ds_read_b64_tr_b16 v[92:93], v8 offset:26624
  ds_read_b64_tr_b16 v[94:95], v9 offset:26624
  ds_read_b64_tr_b16 v[96:97], v8 offset:28672
  ds_read_b64_tr_b16 v[98:99], v9 offset:28672
  ds_read_b64_tr_b16 v[100:101], v8 offset:36864
  ds_read_b64_tr_b16 v[102:103], v9 offset:36864
  ds_read_b64_tr_b16 v[104:105], v8 offset:38912
  ds_read_b64_tr_b16 v[106:107], v9 offset:38912
  ds_read_b64_tr_b16 v[108:109], v8 offset:40960
  ds_read_b64_tr_b16 v[110:111], v9 offset:40960
  v_mov_b32 v6, v57
  v_mov_b32 v7, v58
  v_subrev_u32 v63, 49152, v57
  v_mbcnt_lo_u32_b32 v2, -1, 0
  v_mbcnt_hi_u32_b32 v2, -1, v2
  v_lshlrev_b32 v0, 4, v2
  v_lshrrev_b32 v3, 4, v2
  s_mul_i32 s45, s41, 6144
  s_add_u32 s46, s45, 524288
  buffer_load_dwordx4 v[32:35], v0, s[12:15], s46 offen sc1
  s_add_u32 s46, s45, 525312
  buffer_load_dwordx4 v[36:39], v0, s[12:15], s46 offen sc1
  s_add_u32 s46, s45, 526336
  buffer_load_dwordx4 v[40:43], v0, s[12:15], s46 offen sc1
  s_add_u32 s46, s45, 527360
  buffer_load_dwordx4 v[44:47], v0, s[12:15], s46 offen sc1
  s_add_u32 s46, s45, 528384
  buffer_load_dwordx4 v[48:51], v0, s[12:15], s46 offen sc1
  s_add_u32 s46, s45, 529408
  buffer_load_dwordx4 v[52:55], v0, s[12:15], s46 offen sc1
  v_add_u32 v62, 49152, v0
  v_add_u32 v61, s45, v62
  v_and_b32 v1, 15, v2
  v_mul_u32_u24 v60, 192, v1
  v_lshl_add_u32 v60, v3, 4, v60
  s_mul_i32 s45, s41, 384
  s_add_u32 s45, s45, 147456
  v_lshl_add_u32 v59, v3, 5, s45
  s_mul_i32 s60, s41, 73728
  s_add_u32 s60, s60, s42
  s_add_u32 s60, s60, 301056
  s_mul_i32 s61, s41, 73728
  s_add_u32 s61, s61, s42
  s_add_u32 s61, s61, 592896
  s_mul_i32 s62, s41, 73728
  s_add_u32 s62, s62, s42
  s_add_u32 s62, s62, 3072
  s_mul_i32 s63, s41, 73728
  s_add_u32 s63, s63, s42
  s_add_u32 s63, s63, 297984
  s_mul_i32 s82, s41, 73728
  s_add_u32 s82, s82, s42
  s_add_u32 s82, s82, 595968
  s_waitcnt lgkmcnt(0)
  s_barrier
  s_cmp_eq_u32 s40, 3
  s_cbranch_scc1 L_AR
  ds_read_b64_tr_b16 v[112:113], v6 offset:0
  ds_read_b64_tr_b16 v[114:115], v7 offset:0
  ds_read_b64_tr_b16 v[116:117], v6 offset:2048
  ds_read_b64_tr_b16 v[118:119], v7 offset:2048
  ds_read_b64_tr_b16 v[120:121], v6 offset:4096
  ds_read_b64_tr_b16 v[122:123], v7 offset:4096
  ds_read_b64_tr_b16 v[124:125], v6 offset:6144
  ds_read_b64_tr_b16 v[126:127], v7 offset:6144
  ds_read_b64_tr_b16 v[128:129], v6 offset:8192
  ds_read_b64_tr_b16 v[130:131], v7 offset:8192
  ds_read_b64_tr_b16 v[132:133], v6 offset:10240
  ds_read_b64_tr_b16 v[134:135], v7 offset:10240
  ds_read_b64_tr_b16 v[136:137], v6 offset:12288
  ds_read_b64_tr_b16 v[138:139], v7 offset:12288
  ds_read_b64_tr_b16 v[140:141], v6 offset:14336
  ds_read_b64_tr_b16 v[142:143], v7 offset:14336
  ds_read_b64_tr_b16 v[144:145], v6 offset:16384
  ds_read_b64_tr_b16 v[146:147], v7 offset:16384
  ds_read_b64_tr_b16 v[148:149], v6 offset:18432
  ds_read_b64_tr_b16 v[150:151], v7 offset:18432
  ds_read_b64_tr_b16 v[152:153], v6 offset:20480
  ds_read_b64_tr_b16 v[154:155], v7 offset:20480
  ds_read_b64_tr_b16 v[156:157], v6 offset:22528
  ds_read_b64_tr_b16 v[158:159], v7 offset:22528
  s_waitcnt vmcnt(0)
  v_lshlrev_b32 v16, 16, v32
  v_and_b32 v17, 0xffff0000, v32
  v_lshlrev_b32 v18, 16, v33
  v_and_b32 v19, 0xffff0000, v33
  v_lshlrev_b32 v20, 16, v34
  v_and_b32 v21, 0xffff0000, v34
  v_lshlrev_b32 v22, 16, v35
  v_and_b32 v23, 0xffff0000, v35
  v_lshlrev_b32 v24, 16, v36
  v_and_b32 v25, 0xffff0000, v36
  v_lshlrev_b32 v26, 16, v37
  v_and_b32 v27, 0xffff0000, v37
  v_lshlrev_b32 v28, 16, v38
  v_and_b32 v29, 0xffff0000, v38
  v_lshlrev_b32 v30, 16, v39
  v_and_b32 v31, 0xffff0000, v39
  v_lshlrev_b32 v32, 16, v40
  v_and_b32 v33, 0xffff0000, v40
  v_lshlrev_b32 v34, 16, v41
  v_and_b32 v35, 0xffff0000, v41
  v_lshlrev_b32 v36, 16, v42
  v_and_b32 v37, 0xffff0000, v42
  v_lshlrev_b32 v38, 16, v43
  v_and_b32 v39, 0xffff0000, v43
  v_lshlrev_b32 v40, 16, v44
  v_and_b32 v41, 0xffff0000, v44
  v_lshlrev_b32 v42, 16, v45
  v_and_b32 v43, 0xffff0000, v45
  v_lshlrev_b32 v44, 16, v46
  v_and_b32 v45, 0xffff0000, v46
  v_lshlrev_b32 v46, 16, v47
  v_and_b32 v47, 0xffff0000, v47
  s_branch L_PREPG
L_AR:
  buffer_load_dwordx3 v[56:58], v152, s[28:31], 0 offen
  s_sub_u32 s85, s2, 104
  s_cmp_ge_u32 s85, 48
  s_cbranch_scc1 L_POLL
  v_lshlrev_b32 v1, 4, v2
  s_lshl_b32 s45, s85, 13
  s_add_u32 s47, s45, 4096
  s_mov_b32 s46, 200000
L_R1:
  buffer_load_dwordx4 v[112:115], v1, s[12:15], s45 offen offset:0 sc1
  buffer_load_dwordx4 v[116:119], v1, s[12:15], s45 offen offset:1024 sc1
  buffer_load_dwordx4 v[120:123], v1, s[12:15], s45 offen offset:2048 sc1
  buffer_load_dwordx4 v[124:127], v1, s[12:15], s45 offen offset:3072 sc1
  buffer_load_dwordx4 v[128:131], v1, s[12:15], s47 offen offset:0 sc1
  buffer_load_dwordx4 v[132:135], v1, s[12:15], s47 offen offset:1024 sc1
  buffer_load_dwordx4 v[136:139], v1, s[12:15], s47 offen offset:2048 sc1
  buffer_load_dwordx4 v[140:143], v1, s[12:15], s47 offen offset:3072 sc1
  s_waitcnt vmcnt(0)
  v_or3_b32 v0, v112, v113, v114
  v_or3_b32 v3, v115, v116, v117
  v_or3_b32 v0, v0, v118, v119
  v_or3_b32 v3, v3, v120, v121
  v_or3_b32 v0, v0, v122, v123
  v_or3_b32 v3, v3, v124, v125
  v_or3_b32 v0, v0, v126, v127
  v_or3_b32 v3, v3, v128, v129
  v_or3_b32 v0, v0, v130, v131
  v_or3_b32 v3, v3, v132, v133
  v_or3_b32 v0, v0, v134, v135
  v_or3_b32 v3, v3, v136, v137
  v_or3_b32 v0, v0, v138, v139
  v_or3_b32 v3, v3, v140, v141
  v_or3_b32 v0, v0, v142, v143
  v_or_b32 v0, v0, v3
  v_cmp_gt_i32 vcc, 0, v0
  s_cbranch_vccz L_R2
  s_mov_b64 exec, vcc
  s_sub_u32 s46, s46, 1
  s_cmp_lg_u32 s46, 0
  s_cbranch_scc1 L_R1
L_R2:
  s_mov_b64 exec, -1
  s_setprio 3
  v_pk_add_f32 v[112:113], v[112:113], v[128:129]
  v_pk_add_f32 v[114:115], v[114:115], v[130:131]
  v_pk_add_f32 v[116:117], v[116:117], v[132:133]
  v_pk_add_f32 v[118:119], v[118:119], v[134:135]
  v_pk_add_f32 v[120:121], v[120:121], v[136:137]
  v_pk_add_f32 v[122:123], v[122:123], v[138:139]
  v_pk_add_f32 v[124:125], v[124:125], v[140:141]
  v_pk_add_f32 v[126:127], v[126:127], v[142:143]
  v_pk_add_f32 v[112:113], v[112:113], v[120:121]
  v_pk_add_f32 v[114:115], v[114:115], v[122:123]
  v_pk_add_f32 v[116:117], v[116:117], v[124:125]
  v_pk_add_f32 v[118:119], v[118:119], v[126:127]
  v_pk_add_f32 v[112:113], v[112:113], v[116:117]
  v_pk_add_f32 v[114:115], v[114:115], v[118:119]
  s_nop 1
  v_add_f32_dpp v112, v112, v112 row_ror:4 row_mask:0xf bank_mask:0xf
  v_add_f32_dpp v113, v113, v113 row_ror:4 row_mask:0xf bank_mask:0xf
  v_add_f32_dpp v114, v114, v114 row_ror:4 row_mask:0xf bank_mask:0xf
  v_add_f32_dpp v115, v115, v115 row_ror:4 row_mask:0xf bank_mask:0xf
  v_add_f32_dpp v112, v112, v112 row_ror:8 row_mask:0xf bank_mask:0xf
  v_add_f32_dpp v113, v113, v113 row_ror:8 row_mask:0xf bank_mask:0xf
  v_add_f32_dpp v114, v114, v114 row_ror:8 row_mask:0xf bank_mask:0xf
  v_add_f32_dpp v115, v115, v115 row_ror:8 row_mask:0xf bank_mask:0xf
  v_mov_b32 v116, v112
  v_mov_b32 v117, v113
  v_mov_b32 v118, v114
  v_mov_b32 v119, v115
  s_nop 1
  v_permlane16_swap_b32 v112, v116
  v_permlane16_swap_b32 v113, v117
  v_permlane16_swap_b32 v114, v118
  v_permlane16_swap_b32 v115, v119
  s_nop 1
  v_add_f32 v112, v112, v116
  v_add_f32 v113, v113, v117
  v_add_f32 v114, v114, v118
  v_add_f32 v115, v115, v119
  v_mov_b32 v116, v112
  v_mov_b32 v117, v113
  v_mov_b32 v118, v114
  v_mov_b32 v119, v115
  s_nop 1
  v_permlane32_swap_b32 v112, v116
  v_permlane32_swap_b32 v113, v117
  v_permlane32_swap_b32 v114, v118
  v_permlane32_swap_b32 v115, v119
  s_nop 1
  v_add_f32 v112, v112, v116
  v_add_f32 v113, v113, v117
  v_add_f32 v114, v114, v118
  v_add_f32 v115, v115, v119
  v_and_b32 v112, 0x7fffffff, v112
  v_and_b32 v113, 0x7fffffff, v113
  v_and_b32 v114, 0x7fffffff, v114
  v_and_b32 v115, 0x7fffffff, v115
  v_lshrrev_b32 v3, 2, v2
  v_mul_u32_u24 v3, 3072, v3
  v_and_b32 v0, 3, v2
  v_lshl_add_u32 v3, v0, 4, v3
  v_cmp_gt_u32 vcc, 32, v2
  v_mov_b32 v0, 0x40000000
  s_lshl_b32 s45, s85, 6
  s_add_u32 s45, s45, 393216
  v_cndmask_b32 v3, v0, v3, vcc
  buffer_store_dwordx4 v[112:115], v3, s[12:15], s45 offen sc1
  s_nop 1
L_POLL:
  s_setprio 3
  ds_read_b64_tr_b16 v[112:113], v6 offset:0
  ds_read_b64_tr_b16 v[114:115], v7 offset:0
  ds_read_b64_tr_b16 v[116:117], v6 offset:2048
  ds_read_b64_tr_b16 v[118:119], v7 offset:2048
  ds_read_b64_tr_b16 v[120:121], v6 offset:4096
  ds_read_b64_tr_b16 v[122:123], v7 offset:4096
  ds_read_b64_tr_b16 v[124:125], v6 offset:6144
  ds_read_b64_tr_b16 v[126:127], v7 offset:6144
  ds_read_b64_tr_b16 v[128:129], v6 offset:8192
  ds_read_b64_tr_b16 v[130:131], v7 offset:8192
  ds_read_b64_tr_b16 v[132:133], v6 offset:10240
  ds_read_b64_tr_b16 v[134:135], v7 offset:10240
  ds_read_b64_tr_b16 v[136:137], v6 offset:12288
  ds_read_b64_tr_b16 v[138:139], v7 offset:12288
  ds_read_b64_tr_b16 v[140:141], v6 offset:14336
  ds_read_b64_tr_b16 v[142:143], v7 offset:14336
  ds_read_b64_tr_b16 v[144:145], v6 offset:16384
  ds_read_b64_tr_b16 v[146:147], v7 offset:16384
  ds_read_b64_tr_b16 v[148:149], v6 offset:18432
  ds_read_b64_tr_b16 v[150:151], v7 offset:18432
  ds_read_b64_tr_b16 v[152:153], v6 offset:20480
  ds_read_b64_tr_b16 v[154:155], v7 offset:20480
  ds_read_b64_tr_b16 v[156:157], v6 offset:22528
  ds_read_b64_tr_b16 v[158:159], v7 offset:22528
  s_waitcnt vmcnt(1)
  v_lshlrev_b32 v16, 16, v32
  v_and_b32 v17, 0xffff0000, v32
  v_lshlrev_b32 v18, 16, v33
  v_and_b32 v19, 0xffff0000, v33
  v_lshlrev_b32 v20, 16, v34
  v_and_b32 v21, 0xffff0000, v34
  v_lshlrev_b32 v22, 16, v35
  v_and_b32 v23, 0xffff0000, v35
  v_lshlrev_b32 v24, 16, v36
  v_and_b32 v25, 0xffff0000, v36
  v_lshlrev_b32 v26, 16, v37
  v_and_b32 v27, 0xffff0000, v37
  v_lshlrev_b32 v28, 16, v38
  v_and_b32 v29, 0xffff0000, v38
  v_lshlrev_b32 v30, 16, v39
  v_and_b32 v31, 0xffff0000, v39
  v_lshlrev_b32 v32, 16, v40
  v_and_b32 v33, 0xffff0000, v40
  v_lshlrev_b32 v34, 16, v41
  v_and_b32 v35, 0xffff0000, v41
  v_lshlrev_b32 v36, 16, v42
  v_and_b32 v37, 0xffff0000, v42
  v_lshlrev_b32 v38, 16, v43
  v_and_b32 v39, 0xffff0000, v43
  v_lshlrev_b32 v40, 16, v44
  v_and_b32 v41, 0xffff0000, v44
  v_lshlrev_b32 v42, 16, v45
  v_and_b32 v43, 0xffff0000, v45
  v_lshlrev_b32 v44, 16, v46
  v_and_b32 v45, 0xffff0000, v46
  v_lshlrev_b32 v46, 16, v47
  v_and_b32 v47, 0xffff0000, v47
  v_mul_u32_u24 v3, 24, v2
  s_and_b32 s45, s2, 7
  s_mul_i32 s45, s45, 3072
  s_add_u32 s45, s45, 393216
  s_mov_b32 s46, 200000
L_P1:
  buffer_load_dwordx3 v[0:2], v3, s[12:15], s45 offen offset:0 sc1
  buffer_load_dwordx3 v[4:6], v3, s[12:15], s45 offen offset:12 sc1
  buffer_load_dwordx3 v[8:10], v3, s[12:15], s45 offen offset:1536 sc1
  buffer_load_dwordx3 v[12:14], v3, s[12:15], s45 offen offset:1548 sc1
  s_waitcnt vmcnt(0)
  v_or3_b32 v7, v0, v1, v2
  v_or3_b32 v11, v4, v5, v6
  v_or3_b32 v7, v7, v8, v9
  v_or3_b32 v11, v11, v10, v12
  v_or3_b32 v7, v7, v13, v14
  v_or_b32 v7, v7, v11
  v_cmp_gt_i32 vcc, 0, v7
  s_cbranch_vccz L_P2
  s_mov_b64 exec, vcc
  s_sleep 0
  s_sub_u32 s46, s46, 1
  s_cmp_lg_u32 s46, 0
  s_cbranch_scc1 L_P1
L_P2:
  s_mov_b64 exec, -1
  s_mov_b32 s46, 0x2891afa4
  v_mov_b32 v15, 0x358637bd
  v_add_f32 v0, v0, v8
  v_add_f32 v1, v1, v9
  v_add_f32 v2, v2, v10
  v_add_f32 v4, v4, v12
  v_add_f32 v5, v5, v13
  v_add_f32 v6, v6, v14
  v_fma_f32 v0, v0, s46, v15
  v_fma_f32 v1, v1, s46, v15
  v_fma_f32 v2, v2, s46, v15
  v_fma_f32 v4, v4, s46, v15
  v_fma_f32 v5, v5, s46, v15
  v_fma_f32 v6, v6, s46, v15
  v_sqrt_f32 v0, v0
  v_sqrt_f32 v1, v1
  v_sqrt_f32 v2, v2
  v_sqrt_f32 v4, v4
  v_sqrt_f32 v5, v5
  v_sqrt_f32 v6, v6
  v_lshlrev_b32 v8, 16, v56
  v_add_f32 v7, v0, v1
  v_add_f32 v14, v2, v4
  v_add_f32 v11, v5, v6
  v_add_f32 v7, v7, v14
  v_add_f32 v7, v7, v11
  s_nop 1
  v_add_f32_dpp v7, v7, v7 row_ror:1 row_mask:0xf bank_mask:0xf
  s_nop 1
  v_add_f32_dpp v7, v7, v7 row_ror:2 row_mask:0xf bank_mask:0xf
  s_nop 1
  v_add_f32_dpp v7, v7, v7 row_ror:4 row_mask:0xf bank_mask:0xf
  s_nop 1
  v_add_f32_dpp v7, v7, v7 row_ror:8 row_mask:0xf bank_mask:0xf
  s_nop 1
  v_mov_b32 v14, v7
  s_nop 1
  v_permlane16_swap_b32 v7, v14
  s_nop 1
  v_add_f32 v7, v7, v14
  v_mov_b32 v14, v7
  s_nop 1
  v_permlane32_swap_b32 v7, v14
  s_nop 1
  v_add_f32 v7, v7, v14
  s_mov_b32 s46, 0x3b2aaaab
  v_fma_f32 v7, v7, s46, v15
  v_rcp_f32 v7, v7
  v_and_b32 v9, 0xffff0000, v56
  v_lshlrev_b32 v10, 16, v57
  v_and_b32 v11, 0xffff0000, v57
  v_lshlrev_b32 v12, 16, v58
  v_and_b32 v13, 0xffff0000, v58
  s_mov_b32 s46, 0x34088e99
  v_mov_b32 v14, s46
  v_mul_f32 v7, s46, v7
  v_mul_f32 v8, v0, v8
  v_mul_f32 v9, v1, v9
  v_mul_f32 v10, v2, v10
  v_mul_f32 v11, v4, v11
  v_mul_f32 v12, v5, v12
  v_mul_f32 v13, v6, v13
  v_fma_f32 v8, v8, v7, v14
  v_fma_f32 v9, v9, v7, v14
  v_fma_f32 v10, v10, v7, v14
  v_fma_f32 v11, v11, v7, v14
  v_fma_f32 v12, v12, v7, v14
  v_fma_f32 v13, v13, v7, v14
  v_add_u32 v3, 147456, v3
  ds_write_b64 v3, v[8:9] offset:0
  ds_write_b64 v3, v[10:11] offset:8
  ds_write_b64 v3, v[12:13] offset:16
  s_setprio 0
  s_branch L_PREPG
L_GOWN:
  s_cmp_eq_u32 s83, -2
  s_cbranch_scc1 L_GOWNC
  s_waitcnt vmcnt(0)
  s_cmp_eq_u32 s83, -4
  s_cbranch_scc1 L_GOWNB
L_GOWNA:
  ds_read_b64_tr_b16 v[160:161], v57 offset:0
  ds_read_b64_tr_b16 v[162:163], v58 offset:0
  ds_read_b64_tr_b16 v[164:165], v57 offset:2048
  ds_read_b64_tr_b16 v[166:167], v58 offset:2048
  ds_read_b64_tr_b16 v[168:169], v57 offset:4096
  ds_read_b64_tr_b16 v[170:171], v58 offset:4096
  ds_read_b64_tr_b16 v[172:173], v57 offset:6144
  ds_read_b64_tr_b16 v[174:175], v58 offset:6144
  ds_read_b64_tr_b16 v[176:177], v57 offset:8192
  ds_read_b64_tr_b16 v[178:179], v58 offset:8192
  ds_read_b64_tr_b16 v[180:181], v57 offset:10240
  ds_read_b64_tr_b16 v[182:183], v58 offset:10240
  ds_read_b64_tr_b16 v[184:185], v57 offset:12288
  ds_read_b64_tr_b16 v[186:187], v58 offset:12288
  ds_read_b64_tr_b16 v[188:189], v57 offset:14336
  ds_read_b64_tr_b16 v[190:191], v58 offset:14336
  ds_read_b64_tr_b16 v[192:193], v57 offset:16384
  ds_read_b64_tr_b16 v[194:195], v58 offset:16384
  ds_read_b64_tr_b16 v[196:197], v57 offset:18432
  ds_read_b64_tr_b16 v[198:199], v58 offset:18432
  ds_read_b64_tr_b16 v[200:201], v57 offset:20480
  ds_read_b64_tr_b16 v[202:203], v58 offset:20480
  ds_read_b64_tr_b16 v[204:205], v57 offset:22528
  ds_read_b64_tr_b16 v[206:207], v58 offset:22528
  v_subrev_u32 v57, 49152, v57
  v_subrev_u32 v58, 49152, v58
  s_setpc_b64 s[100:101]
L_GOWNB:
  ds_read_b64_tr_b16 v[208:209], v57 offset:0
  ds_read_b64_tr_b16 v[210:211], v58 offset:0
  ds_read_b64_tr_b16 v[212:213], v57 offset:2048
  ds_read_b64_tr_b16 v[214:215], v58 offset:2048
  ds_read_b64_tr_b16 v[216:217], v57 offset:4096
  ds_read_b64_tr_b16 v[218:219], v58 offset:4096
  ds_read_b64_tr_b16 v[220:221], v57 offset:6144
  ds_read_b64_tr_b16 v[222:223], v58 offset:6144
  ds_read_b64_tr_b16 v[224:225], v57 offset:8192
  ds_read_b64_tr_b16 v[226:227], v58 offset:8192
  ds_read_b64_tr_b16 v[228:229], v57 offset:10240
  ds_read_b64_tr_b16 v[230:231], v58 offset:10240
  ds_read_b64_tr_b16 v[232:233], v57 offset:12288
  ds_read_b64_tr_b16 v[234:235], v58 offset:12288
  ds_read_b64_tr_b16 v[236:237], v57 offset:14336
  ds_read_b64_tr_b16 v[238:239], v58 offset:14336
  ds_read_b64_tr_b16 v[240:241], v57 offset:16384
  ds_read_b64_tr_b16 v[242:243], v58 offset:16384
  ds_read_b64_tr_b16 v[244:245], v57 offset:18432
  ds_read_b64_tr_b16 v[246:247], v58 offset:18432
  ds_read_b64_tr_b16 v[248:249], v57 offset:20480
  ds_read_b64_tr_b16 v[250:251], v58 offset:20480
  ds_read_b64_tr_b16 v[252:253], v57 offset:22528
  ds_read_b64_tr_b16 v[254:255], v58 offset:22528
  s_mul_i32 s58, s41, 6144
  s_add_u32 s58, s58, 49152
  v_add_u32 v57, 49152, v57
  v_add_u32 v58, 49152, v58
  s_setpc_b64 s[100:101]
L_GOWNC:
  v_subrev_u32 v55, 18432, v55
  v_subrev_u32 v56, 18432, v56
  s_mul_i32 s59, s41, 6144
  s_sub_u32 s59, 0xfffec800, s59
  s_setpc_b64 s[100:101]
  .p2align 6
L_H:
  s_setprio 1
  v_mul_u32_u24 v3, 86, v2
  v_lshrrev_b32 v3, 8, v3
  v_mul_u32_u24 v4, 3, v3
  v_sub_u32 v4, v2, v4
  v_mul_u32_u24 v5, 192, v3
  v_lshl_add_u32 v5, v4, 4, v5
  s_mul_i32 s45, s41, 48
  v_add_u32 v5, s45, v5
  v_mov_b32 v6, 0x40000000
  v_cmp_gt_u32 vcc, 54, v2
  s_nop 1
  v_cndmask_b32 v57, v6, v5, vcc
  s_cmp_eq_u32 s47, 0
  s_cselect_b32 s46, 0, 99
  v_cmp_eq_u32 vcc, s46, v3
  s_nop 1
  v_cndmask_b32 v56, v57, v6, vcc
  s_cmp_eq_u32 s47, 7
  s_cselect_b32 s46, 17, 99
  v_cmp_eq_u32 vcc, s46, v3
  s_nop 1
  v_cndmask_b32 v58, v57, v6, vcc
  s_mul_i32 s49, s41, 12288
  s_add_u32 s49, s49, 98304
  v_lshrrev_b32 v3, 4, v2
  v_bfe_u32 v4, v2, 3, 1
  v_sub_u32 v3, v3, v4
  v_and_b32 v4, 7, v2
  v_mul_u32_u24 v5, 576, v3
  v_lshl_add_u32 v5, v4, 1, v5
  v_add_u32 v5, s45, v5
  v_cmp_gt_u32 vcc, 3, v3
  s_nop 1
  v_cndmask_b32 v5, v6, v5, vcc
  s_waitcnt lgkmcnt(0)
  s_sub_u32 s4, s64, 192
  s_subb_u32 s5, s65, 0
  s_mov_b64 s[24:25], s[66:67]
  s_mov_b64 s[16:17], s[68:69]
  s_mov_b64 s[20:21], s[70:71]
  s_mov_b64 s[28:29], s[72:73]
  s_mov_b64 s[32:33], s[74:75]
  s_mov_b64 s[8:9], s[76:77]
  s_mov_b64 s[36:37], s[78:79]
  s_mov_b64 s[12:13], s[80:81]
  buffer_load_ushort v24, v5, s[24:27], 0 offen offset:0
  buffer_load_ushort v25, v5, s[24:27], 0 offen offset:192
  buffer_load_ushort v26, v5, s[24:27], 0 offen offset:384
  buffer_load_ushort v27, v5, s[24:27], 0 offen offset:16
  buffer_load_ushort v28, v5, s[24:27], 0 offen offset:208
  buffer_load_ushort v29, v5, s[24:27], 0 offen offset:400
  buffer_load_ushort v30, v5, s[24:27], 0 offen offset:32
  buffer_load_ushort v31, v5, s[24:27], 0 offen offset:224
  buffer_load_ushort v32, v5, s[24:27], 0 offen offset:416
  s_add_u32 m0, s49, 8192
  s_add_u32 s45, s43, 0
  buffer_load_dwordx4 v56, s[4:7], s45 offen lds
  s_add_u32 m0, s49, 9216
  s_add_u32 s45, s42, 0
  buffer_load_dwordx4 v56, s[4:7], s45 offen lds
  s_add_u32 m0, s49, 0
  s_add_u32 s45, s42, 73728
  buffer_load_dwordx4 v56, s[4:7], s45 offen lds
  s_add_u32 m0, s49, 1024
  s_add_u32 s45, s42, 147456
  buffer_load_dwordx4 v56, s[4:7], s45 offen lds
  s_add_u32 m0, s49, 2048
  s_add_u32 s45, s42, 221184
  buffer_load_dwordx4 v56, s[4:7], s45 offen lds
  s_add_u32 m0, s49, 3072
  s_add_u32 s45, s42, 294912
  buffer_load_dwordx4 v56, s[4:7], s45 offen lds
  v_mov_b32 v14, v57
  v_mov_b32 v15, v58
  v_mov_b32 v57, 49152
  v_mov_b32 v58, 49152
  s_call_b64 s[100:101], L_GOWNA
  s_call_b64 s[100:101], L_GOWNB
  v_mov_b32 v57, v14
  v_mov_b32 v58, v15
  s_waitcnt lgkmcnt(0)
  v_lshrrev_b32 v212, 4, v2
  v_mul_u32_u24 v212, 1536, v212
  v_bfe_u32 v213, v2, 2, 2
  v_lshl_add_u32 v212, v213, 4, v212
  v_and_b32 v213, 3, v2
  v_lshl_add_u32 v212, v213, 1, v212
  v_lshlrev_b32 v213, 4, v2
  v_mov_b32 v224, -1
  v_mov_b32 v225, -1
  v_mov_b32 v226, -1
  v_mov_b32 v227, -1
  v_lshrrev_b32 v3, 4, v2
  v_lshlrev_b32 v3, 13, v3
  v_and_b32 v4, 15, v2
  v_lshl_add_u32 v228, v4, 2, v3
  v_cmp_gt_u32 vcc, 32, v2
  v_lshrrev_b32 v3, 2, v2
  v_mul_u32_u24 v3, 3072, v3
  v_cndmask_b32 v229, v6, v228, vcc
  v_and_b32 v4, 3, v2
  v_lshl_add_u32 v3, v4, 4, v3
  v_cndmask_b32 v230, v6, v3, vcc
  v_min_u32 v3, 11, v2
  v_mul_u32_u24 v231, 73728, v3
  v_and_b32 v244, 0x30, v2
  v_and_b32 v3, 15, v2
  v_cmp_eq_u32 vcc, 0, v3
  v_lshlrev_b32 v4, 1, v244
  s_nop 0
  v_cndmask_b32 v245, v6, v4, vcc
  v_cmp_eq_u32 vcc, 0, v2
  v_mov_b32 v215, 1
  s_nop 0
  v_cndmask_b32 v214, v6, v2, vcc
  v_and_b32 v7, 1, v2
  v_lshlrev_b32 v7, 4, v7
  v_mov_b32 v12, 0xffff
  v_lshlrev_b32 v12, v7, v12
  v_bfe_u32 v13, v2, 1, 2
  v_cmp_eq_u32 vcc, 0, v13
  s_nop 1
  v_cndmask_b32 v8, 0, v12, vcc
  v_cmp_eq_u32 vcc, 1, v13
  s_nop 1
  v_cndmask_b32 v9, 0, v12, vcc
  v_cmp_eq_u32 vcc, 2, v13
  s_nop 1
  v_cndmask_b32 v10, 0, v12, vcc
  v_cmp_eq_u32 vcc, 3, v13
  s_nop 1
  v_cndmask_b32 v11, 0, v12, vcc
  v_and_b32 v3, 15, v2
  v_lshrrev_b32 v4, 4, v2
  v_mul_u32_u24 v5, 48, v3
  v_add_u32 v5, s49, v5
  v_lshl_add_u32 v54, v4, 10, v5
  v_add_u32 v14, 8, v4
  v_subrev_u32 v15, 10, v14
  v_min_u32 v14, v14, v15
  v_lshl_add_u32 v55, v14, 10, v5
  v_lshrrev_b32 v14, 5, v2
  v_lshl_add_u32 v14, v14, 4, v3
  v_and_b32 v15, 1, v4
  v_lshlrev_b32 v60, 3, v14
  v_add_u32 v60, 108544, v60
  s_lshl_b32 s45, s41, 9
  v_lshl_add_u32 v59, v15, 8, v60
  v_add_u32 v59, s45, v59
  v_mul_u32_u24 v61, 208, v14
  v_lshl_add_u32 v61, v15, 3, v61
  s_mul_i32 s45, s41, 48
  s_add_u32 s45, s45, 147456
  v_add_u32 v61, s45, v61
  v_lshrrev_b32 v3, 4, v2
  v_bfe_u32 v4, v2, 2, 2
  v_lshl_add_u32 v62, v3, 3, v4
  v_lshlrev_b32 v62, 6, v62
  v_and_b32 v3, 1, v3
  v_lshlrev_b32 v3, 1, v3
  v_lshrrev_b32 v4, 1, v4
  v_xor_b32 v3, v3, v4
  v_bfe_u32 v4, v2, 1, 1
  s_and_b32 s45, s41, 1
  s_lshl_b32 s45, s45, 1
  v_or_b32 v4, s45, v4
  v_xor_b32 v3, v3, v4
  v_lshl_add_u32 v62, v3, 4, v62
  v_and_b32 v4, 1, v2
  v_lshl_add_u32 v62, v4, 3, v62
  s_lshr_b32 s45, s41, 1
  s_mul_i32 s45, s45, 24576
  s_add_u32 s45, s45, 0
  v_add_u32 v62, s45, v62
  v_xor_b32 v63, 32, v62
  v_add_u32 v63, 256, v63
  s_waitcnt vmcnt(6)
  v_lshlrev_b32 v24, v7, v24
  v_and_b32 v64, v24, v8
  v_and_b32 v65, v24, v9
  v_and_b32 v66, v24, v10
  v_and_b32 v67, v24, v11
  v_lshlrev_b32 v25, v7, v25
  v_and_b32 v68, v25, v8
  v_and_b32 v69, v25, v9
  v_and_b32 v70, v25, v10
  v_and_b32 v71, v25, v11
  v_lshlrev_b32 v26, v7, v26
  v_and_b32 v72, v26, v8
  v_and_b32 v73, v26, v9
  v_and_b32 v74, v26, v10
  v_and_b32 v75, v26, v11
  v_lshlrev_b32 v27, v7, v27
  v_and_b32 v76, v27, v8
  v_and_b32 v77, v27, v9
  v_and_b32 v78, v27, v10
  v_and_b32 v79, v27, v11
  v_lshlrev_b32 v28, v7, v28
  v_and_b32 v80, v28, v8
  v_and_b32 v81, v28, v9
  v_and_b32 v82, v28, v10
  v_and_b32 v83, v28, v11
  v_lshlrev_b32 v29, v7, v29
  v_and_b32 v84, v29, v8
  v_and_b32 v85, v29, v9
  v_and_b32 v86, v29, v10
  v_and_b32 v87, v29, v11
  v_lshlrev_b32 v30, v7, v30
  v_and_b32 v88, v30, v8
  v_and_b32 v89, v30, v9
  v_and_b32 v90, v30, v10
  v_and_b32 v91, v30, v11
  v_lshlrev_b32 v31, v7, v31
  v_and_b32 v92, v31, v8
  v_and_b32 v93, v31, v9
  v_and_b32 v94, v31, v10
  v_and_b32 v95, v31, v11
  v_lshlrev_b32 v32, v7, v32
  v_and_b32 v96, v32, v8
  v_and_b32 v97, v32, v9
  v_and_b32 v98, v32, v10
  v_and_b32 v99, v32, v11
  s_waitcnt vmcnt(2)
  ds_read_b128 v[24:27], v55 offset:0
  ds_read_b128 v[28:31], v55 offset:16
  ds_read_b128 v[32:35], v55 offset:32
  ds_read_b128 v[36:39], v55 offset:48
  ds_read_b128 v[40:43], v55 offset:64
  ds_read_b128 v[44:47], v55 offset:80
  ds_read_b128 v[100:103], v55 offset:96
  ds_read_b128 v[104:107], v55 offset:112
  ds_read_b128 v[108:111], v55 offset:128
  s_add_u32 m0, s49, 4096
  s_add_u32 s45, s42, 368640
  buffer_load_dwordx4 v56, s[4:7], s45 offen lds
  s_add_u32 m0, s49, 5120
  s_add_u32 s45, s42, 442368
  buffer_load_dwordx4 v56, s[4:7], s45 offen lds
  s_waitcnt lgkmcnt(0)
  v_mfma_f32_16x16x32_bf16 v[0:3], v[64:67], v[24:27], 0
  v_mfma_f32_16x16x32_bf16 v[4:7], v[76:79], v[28:31], 0
  v_mfma_f32_16x16x32_bf16 v[8:11], v[88:91], v[32:35], 0
  v_mfma_f32_16x16x32_bf16 v[0:3], v[68:71], v[36:39], v[0:3]
  v_mfma_f32_16x16x32_bf16 v[4:7], v[80:83], v[40:43], v[4:7]
  v_mfma_f32_16x16x32_bf16 v[8:11], v[92:95], v[44:47], v[8:11]
  v_mfma_f32_16x16x32_bf16 v[0:3], v[72:75], v[100:103], v[0:3]
  v_mfma_f32_16x16x32_bf16 v[4:7], v[84:87], v[104:107], v[4:7]
  v_mfma_f32_16x16x32_bf16 v[8:11], v[96:99], v[108:111], v[8:11]
  s_waitcnt vmcnt(2)
  ds_read_b128 v[24:27], v54 offset:0
  ds_read_b128 v[28:31], v54 offset:16
  ds_read_b128 v[32:35], v54 offset:32
  ds_read_b128 v[36:39], v54 offset:48
  ds_read_b128 v[40:43], v54 offset:64
  ds_read_b128 v[44:47], v54 offset:80
  ds_read_b128 v[100:103], v54 offset:96
  ds_read_b128 v[104:107], v54 offset:112
  ds_read_b128 v[108:111], v54 offset:128
  v_pk_add_f32 v[48:49], v[0:1], v[2:3]
  v_pk_fma_f32 v[50:51], v[0:1], v[0:1], s[54:55]
  v_pk_fma_f32 v[50:51], v[2:3], v[2:3], v[50:51]
  v_pk_add_f32 v[48:49], v[48:49], v[4:5]
  v_pk_fma_f32 v[50:51], v[4:5], v[4:5], v[50:51]
  v_pk_add_f32 v[48:49], v[48:49], v[6:7]
  v_pk_fma_f32 v[50:51], v[6:7], v[6:7], v[50:51]
  v_pk_add_f32 v[48:49], v[48:49], v[8:9]
  v_pk_fma_f32 v[50:51], v[8:9], v[8:9], v[50:51]
  v_pk_add_f32 v[48:49], v[48:49], v[10:11]
  v_pk_fma_f32 v[50:51], v[10:11], v[10:11], v[50:51]
  v_add_f32 v48, v48, v49
  v_add_f32 v49, v50, v51
  ds_write_b64 v59, v[48:49] offset:0
  s_waitcnt lgkmcnt(1)
  v_mfma_f32_16x16x32_bf16 v[12:15], v[64:67], v[24:27], 0
  v_mfma_f32_16x16x32_bf16 v[16:19], v[76:79], v[28:31], 0
  v_mfma_f32_16x16x32_bf16 v[20:23], v[88:91], v[32:35], 0
  v_mfma_f32_16x16x32_bf16 v[12:15], v[68:71], v[36:39], v[12:15]
  v_mfma_f32_16x16x32_bf16 v[16:19], v[80:83], v[40:43], v[16:19]
  v_mfma_f32_16x16x32_bf16 v[20:23], v[92:95], v[44:47], v[20:23]
  v_mfma_f32_16x16x32_bf16 v[12:15], v[72:75], v[100:103], v[12:15]
  v_mfma_f32_16x16x32_bf16 v[16:19], v[84:87], v[104:107], v[16:19]
  v_mfma_f32_16x16x32_bf16 v[20:23], v[96:99], v[108:111], v[20:23]
  s_nop 7
  v_pk_add_f32 v[48:49], v[12:13], v[14:15]
  v_pk_fma_f32 v[50:51], v[12:13], v[12:13], s[54:55]
  v_pk_fma_f32 v[50:51], v[14:15], v[14:15], v[50:51]
  v_pk_add_f32 v[48:49], v[48:49], v[16:17]
  v_pk_fma_f32 v[50:51], v[16:17], v[16:17], v[50:51]
  v_pk_add_f32 v[48:49], v[48:49], v[18:19]
  v_pk_fma_f32 v[50:51], v[18:19], v[18:19], v[50:51]
  v_pk_add_f32 v[48:49], v[48:49], v[20:21]
  v_pk_fma_f32 v[50:51], v[20:21], v[20:21], v[50:51]
  v_pk_add_f32 v[48:49], v[48:49], v[22:23]
  v_pk_fma_f32 v[50:51], v[22:23], v[22:23], v[50:51]
  v_add_f32 v48, v48, v49
  v_add_f32 v49, v50, v51
  ds_write_b64 v59, v[48:49] offset:12288
  s_waitcnt lgkmcnt(0)
  s_barrier
  ds_read_b64 v[24:25], v60 offset:0
  ds_read_b64 v[26:27], v60 offset:256
  ds_read_b64 v[28:29], v60 offset:512
  ds_read_b64 v[30:31], v60 offset:768
  ds_read_b64 v[32:33], v60 offset:1024
  ds_read_b64 v[34:35], v60 offset:1280
  ds_read_b64 v[48:49], v60 offset:1536
  ds_read_b64 v[50:51], v60 offset:1792
  s_waitcnt lgkmcnt(0)
  v_pk_add_f32 v[24:25], v[24:25], v[32:33]
  v_pk_add_f32 v[26:27], v[26:27], v[34:35]
  v_pk_add_f32 v[28:29], v[28:29], v[48:49]
  v_pk_add_f32 v[30:31], v[30:31], v[50:51]
  v_pk_add_f32 v[24:25], v[24:25], v[28:29]
  v_pk_add_f32 v[26:27], v[26:27], v[30:31]
  v_pk_add_f32 v[24:25], v[24:25], v[26:27]
  v_pk_mul_f32 v[24:25], v[24:25], s[52:53]
  v_fma_f32 v25, -v24, v24, v25
  v_max_f32 v25, s57, v25
  v_rsq_f32 v25, v25
  s_nop 0
  v_mul_f32 v52, s56, v25
  v_mul_f32 v53, -v24, v52
  v_pk_fma_f32 v[0:1], v[0:1], v[52:53], v[52:53] op_sel:[0,0,1] op_sel_hi:[1,0,1]
  v_pk_fma_f32 v[2:3], v[2:3], v[52:53], v[52:53] op_sel:[0,0,1] op_sel_hi:[1,0,1]
  v_pk_fma_f32 v[4:5], v[4:5], v[52:53], v[52:53] op_sel:[0,0,1] op_sel_hi:[1,0,1]
  v_pk_fma_f32 v[6:7], v[6:7], v[52:53], v[52:53] op_sel:[0,0,1] op_sel_hi:[1,0,1]
  v_pk_fma_f32 v[8:9], v[8:9], v[52:53], v[52:53] op_sel:[0,0,1] op_sel_hi:[1,0,1]
  v_pk_fma_f32 v[10:11], v[10:11], v[52:53], v[52:53] op_sel:[0,0,1] op_sel_hi:[1,0,1]
  v_cvt_pk_bf16_f32 v0, v0, v1
  v_cvt_pk_bf16_f32 v1, v2, v3
  v_cvt_pk_bf16_f32 v2, v4, v5
  v_cvt_pk_bf16_f32 v3, v6, v7
  v_cvt_pk_bf16_f32 v4, v8, v9
  v_cvt_pk_bf16_f32 v5, v10, v11
  ds_write_b64 v61, v[0:1] offset:0
  ds_write_b64 v61, v[2:3] offset:16
  ds_write_b64 v61, v[4:5] offset:32
  s_waitcnt lgkmcnt(0)
  s_barrier
  s_add_u32 m0, s49, 6144
  s_add_u32 s45, s42, 516096
  buffer_load_dwordx4 v56, s[4:7], s45 offen lds
  s_add_u32 m0, s49, 7168
  s_add_u32 s45, s42, 589824
  buffer_load_dwordx4 v56, s[4:7], s45 offen lds
  s_add_u32 m0, s49, 8192
  s_add_u32 s45, s42, 663552
  buffer_load_dwordx4 v56, s[4:7], s45 offen lds
  s_add_u32 m0, s49, 9216
  s_add_u32 s45, s42, 737280
  buffer_load_dwordx4 v56, s[4:7], s45 offen lds
  s_add_u32 m0, s49, 0
  s_add_u32 s45, s42, 811008
  buffer_load_dwordx4 v56, s[4:7], s45 offen lds
  s_add_u32 m0, s49, 1024
  s_add_u32 s45, s44, 0
  buffer_load_dwordx4 v56, s[4:7], s45 offen lds
  s_waitcnt vmcnt(6)
  ds_read_b128 v[24:27], v54 offset:2048
  ds_read_b128 v[28:31], v54 offset:2064
  ds_read_b128 v[32:35], v54 offset:2080
  ds_read_b128 v[36:39], v54 offset:2096
  ds_read_b128 v[40:43], v54 offset:2112
  ds_read_b128 v[44:47], v54 offset:2128
  ds_read_b128 v[100:103], v54 offset:2144
  ds_read_b128 v[104:107], v54 offset:2160
  ds_read_b128 v[108:111], v54 offset:2176
  s_waitcnt lgkmcnt(0)
  v_mfma_f32_16x16x32_bf16 v[0:3], v[64:67], v[24:27], 0
  v_mfma_f32_16x16x32_bf16 v[4:7], v[76:79], v[28:31], 0
  v_mfma_f32_16x16x32_bf16 v[8:11], v[88:91], v[32:35], 0
  ds_read_b64 v[24:25], v60 offset:12288
  ds_read_b64 v[26:27], v60 offset:12544
  ds_read_b64 v[28:29], v60 offset:12800
  ds_read_b64 v[30:31], v60 offset:13056
  ds_read_b64 v[32:33], v60 offset:13312
  ds_read_b64 v[34:35], v60 offset:13568
  ds_read_b64 v[48:49], v60 offset:13824
  ds_read_b64 v[50:51], v60 offset:14080
  s_waitcnt lgkmcnt(0)
  v_pk_add_f32 v[24:25], v[24:25], v[32:33]
  v_pk_add_f32 v[26:27], v[26:27], v[34:35]
  v_pk_add_f32 v[28:29], v[28:29], v[48:49]
  v_pk_add_f32 v[30:31], v[30:31], v[50:51]
  v_pk_add_f32 v[24:25], v[24:25], v[28:29]
  v_pk_add_f32 v[26:27], v[26:27], v[30:31]
  v_pk_add_f32 v[24:25], v[24:25], v[26:27]
  v_pk_mul_f32 v[24:25], v[24:25], s[52:53]
  v_mfma_f32_16x16x32_bf16 v[0:3], v[68:71], v[36:39], v[0:3]
  v_fma_f32 v25, -v24, v24, v25
  v_max_f32 v25, s57, v25
  v_mfma_f32_16x16x32_bf16 v[4:7], v[80:83], v[40:43], v[4:7]
  v_rsq_f32 v25, v25
  v_mfma_f32_16x16x32_bf16 v[8:11], v[92:95], v[44:47], v[8:11]
  v_mul_f32 v52, s56, v25
  v_mul_f32 v53, -v24, v52
  v_pk_fma_f32 v[12:13], v[12:13], v[52:53], v[52:53] op_sel:[0,0,1] op_sel_hi:[1,0,1]
  v_pk_fma_f32 v[14:15], v[14:15], v[52:53], v[52:53] op_sel:[0,0,1] op_sel_hi:[1,0,1]
  v_pk_fma_f32 v[16:17], v[16:17], v[52:53], v[52:53] op_sel:[0,0,1] op_sel_hi:[1,0,1]
  v_pk_fma_f32 v[18:19], v[18:19], v[52:53], v[52:53] op_sel:[0,0,1] op_sel_hi:[1,0,1]
  v_pk_fma_f32 v[20:21], v[20:21], v[52:53], v[52:53] op_sel:[0,0,1] op_sel_hi:[1,0,1]
  v_pk_fma_f32 v[22:23], v[22:23], v[52:53], v[52:53] op_sel:[0,0,1] op_sel_hi:[1,0,1]
  v_mfma_f32_16x16x32_bf16 v[0:3], v[72:75], v[100:103], v[0:3]
  v_cvt_pk_bf16_f32 v12, v12, v13
  v_cvt_pk_bf16_f32 v13, v14, v15
  v_mfma_f32_16x16x32_bf16 v[4:7], v[84:87], v[104:107], v[4:7]
  v_cvt_pk_bf16_f32 v14, v16, v17
  v_cvt_pk_bf16_f32 v15, v18, v19
  v_mfma_f32_16x16x32_bf16 v[8:11], v[96:99], v[108:111], v[8:11]
  v_cvt_pk_bf16_f32 v16, v20, v21
  v_cvt_pk_bf16_f32 v17, v22, v23
  ds_write_b64 v61, v[12:13] offset:6656
  ds_write_b64 v61, v[14:15] offset:6672
  ds_write_b64 v61, v[16:17] offset:6688
  s_waitcnt vmcnt(4)
  ds_read_b128 v[24:27], v54 offset:4096
  ds_read_b128 v[28:31], v54 offset:4112
  ds_read_b128 v[32:35], v54 offset:4128
  ds_read_b128 v[36:39], v54 offset:4144
  ds_read_b128 v[40:43], v54 offset:4160
  ds_read_b128 v[44:47], v54 offset:4176
  ds_read_b128 v[100:103], v54 offset:4192
  ds_read_b128 v[104:107], v54 offset:4208
  ds_read_b128 v[108:111], v54 offset:4224
  v_pk_add_f32 v[48:49], v[0:1], v[2:3]
  v_pk_fma_f32 v[50:51], v[0:1], v[0:1], s[54:55]
  v_pk_fma_f32 v[50:51], v[2:3], v[2:3], v[50:51]
  v_pk_add_f32 v[48:49], v[48:49], v[4:5]
  v_pk_fma_f32 v[50:51], v[4:5], v[4:5], v[50:51]
  v_pk_add_f32 v[48:49], v[48:49], v[6:7]
  v_pk_fma_f32 v[50:51], v[6:7], v[6:7], v[50:51]
  v_pk_add_f32 v[48:49], v[48:49], v[8:9]
  v_pk_fma_f32 v[50:51], v[8:9], v[8:9], v[50:51]
  v_pk_add_f32 v[48:49], v[48:49], v[10:11]
  v_pk_fma_f32 v[50:51], v[10:11], v[10:11], v[50:51]
  v_add_f32 v48, v48, v49
  v_add_f32 v49, v50, v51
  ds_write_b64 v59, v[48:49] offset:0
  s_waitcnt lgkmcnt(1)
  s_add_u32 m0, s49, 2048
  s_add_u32 s45, s43, 3072
  buffer_load_dwordx4 v57, s[4:7], s45 offen lds
  s_add_u32 m0, s49, 3072
  s_add_u32 s45, s42, 3072
  buffer_load_dwordx4 v57, s[4:7], s45 offen lds
  s_add_u32 m0, s49, 4096
  s_add_u32 s45, s42, 76800
  buffer_load_dwordx4 v57, s[4:7], s45 offen lds
  s_add_u32 m0, s49, 5120
  s_add_u32 s45, s42, 150528
  buffer_load_dwordx4 v57, s[4:7], s45 offen lds
  s_waitcnt lgkmcnt(0)
  s_barrier
  v_mfma_f32_16x16x32_bf16 v[12:15], v[64:67], v[24:27], 0
  v_mfma_f32_16x16x32_bf16 v[16:19], v[76:79], v[28:31], 0
  v_mfma_f32_16x16x32_bf16 v[20:23], v[88:91], v[32:35], 0
  ds_read_b64 v[24:25], v60 offset:0
  ds_read_b64 v[26:27], v60 offset:256
  ds_read_b64 v[28:29], v60 offset:512
  ds_read_b64 v[30:31], v60 offset:768
  ds_read_b64 v[32:33], v60 offset:1024
  ds_read_b64 v[34:35], v60 offset:1280
  ds_read_b64 v[48:49], v60 offset:1536
  ds_read_b64 v[50:51], v60 offset:1792
  s_waitcnt lgkmcnt(0)
  v_pk_add_f32 v[24:25], v[24:25], v[32:33]
  v_pk_add_f32 v[26:27], v[26:27], v[34:35]
  v_pk_add_f32 v[28:29], v[28:29], v[48:49]
  v_pk_add_f32 v[30:31], v[30:31], v[50:51]
  v_pk_add_f32 v[24:25], v[24:25], v[28:29]
  v_pk_add_f32 v[26:27], v[26:27], v[30:31]
  v_pk_add_f32 v[24:25], v[24:25], v[26:27]
  v_pk_mul_f32 v[24:25], v[24:25], s[52:53]
  v_mfma_f32_16x16x32_bf16 v[12:15], v[68:71], v[36:39], v[12:15]
  v_fma_f32 v25, -v24, v24, v25
  v_max_f32 v25, s57, v25
  v_mfma_f32_16x16x32_bf16 v[16:19], v[80:83], v[40:43], v[16:19]
  v_rsq_f32 v25, v25
  v_mfma_f32_16x16x32_bf16 v[20:23], v[92:95], v[44:47], v[20:23]
  v_mul_f32 v52, s56, v25
  v_mul_f32 v53, -v24, v52
  v_pk_fma_f32 v[0:1], v[0:1], v[52:53], v[52:53] op_sel:[0,0,1] op_sel_hi:[1,0,1]
  v_pk_fma_f32 v[2:3], v[2:3], v[52:53], v[52:53] op_sel:[0,0,1] op_sel_hi:[1,0,1]
  v_pk_fma_f32 v[4:5], v[4:5], v[52:53], v[52:53] op_sel:[0,0,1] op_sel_hi:[1,0,1]
  v_pk_fma_f32 v[6:7], v[6:7], v[52:53], v[52:53] op_sel:[0,0,1] op_sel_hi:[1,0,1]
  v_pk_fma_f32 v[8:9], v[8:9], v[52:53], v[52:53] op_sel:[0,0,1] op_sel_hi:[1,0,1]
  v_pk_fma_f32 v[10:11], v[10:11], v[52:53], v[52:53] op_sel:[0,0,1] op_sel_hi:[1,0,1]
  v_mfma_f32_16x16x32_bf16 v[12:15], v[72:75], v[100:103], v[12:15]
  v_cvt_pk_bf16_f32 v0, v0, v1
  v_cvt_pk_bf16_f32 v1, v2, v3
  v_mfma_f32_16x16x32_bf16 v[16:19], v[84:87], v[104:107], v[16:19]
  v_cvt_pk_bf16_f32 v2, v4, v5
  v_cvt_pk_bf16_f32 v3, v6, v7
  v_mfma_f32_16x16x32_bf16 v[20:23], v[96:99], v[108:111], v[20:23]
  v_cvt_pk_bf16_f32 v4, v8, v9
  v_cvt_pk_bf16_f32 v5, v10, v11
  ds_write_b64 v61, v[0:1] offset:0
  ds_write_b64 v61, v[2:3] offset:16
  ds_write_b64 v61, v[4:5] offset:32
  s_waitcnt vmcnt(6)
  ds_read_b128 v[24:27], v54 offset:6144
  ds_read_b128 v[28:31], v54 offset:6160
  ds_read_b128 v[32:35], v54 offset:6176
  ds_read_b128 v[36:39], v54 offset:6192
  ds_read_b128 v[40:43], v54 offset:6208
  ds_read_b128 v[44:47], v54 offset:6224
  ds_read_b128 v[100:103], v54 offset:6240
  ds_read_b128 v[104:107], v54 offset:6256
  ds_read_b128 v[108:111], v54 offset:6272
  s_bfe_u32 s46, s2, 0x10002
  s_mul_i32 s46, s46, 24
  s_mul_i32 s45, s41, 6
  s_add_u32 s46, s46, s45
  s_lshl_b32 s46, s46, 13
  s_lshr_b32 s45, s2, 3
  s_lshl_b32 s45, s45, 2
  s_and_b32 s47, s2, 3
  s_add_u32 s45, s45, s47
  s_lshl_b32 s45, s45, 6
  s_add_u32 s46, s46, s45
  s_add_u32 s47, s46, 32768
  buffer_store_dword v224, v228, s[12:15], s46 offen sc1
  buffer_store_dword v224, v229, s[12:15], s47 offen sc1
  s_lshl_b32 s45, s2, 6
  s_add_u32 s45, s45, 393216
  s_cmp_lt_u32 s2, 48
  s_cselect_b32 s45, s45, 0x80000000
  buffer_store_dwordx4 v[224:227], v230, s[12:15], s45 offen sc1
  buffer_load_dword v232, v231, s[8:11], s42 offen nt
  v_pk_add_f32 v[48:49], v[12:13], v[14:15]
  v_pk_fma_f32 v[50:51], v[12:13], v[12:13], s[54:55]
  v_pk_fma_f32 v[50:51], v[14:15], v[14:15], v[50:51]
  v_pk_add_f32 v[48:49], v[48:49], v[16:17]
  v_pk_fma_f32 v[50:51], v[16:17], v[16:17], v[50:51]
  v_pk_add_f32 v[48:49], v[48:49], v[18:19]
  v_pk_fma_f32 v[50:51], v[18:19], v[18:19], v[50:51]
  v_pk_add_f32 v[48:49], v[48:49], v[20:21]
  v_pk_fma_f32 v[50:51], v[20:21], v[20:21], v[50:51]
  v_pk_add_f32 v[48:49], v[48:49], v[22:23]
  v_pk_fma_f32 v[50:51], v[22:23], v[22:23], v[50:51]
  v_add_f32 v48, v48, v49
  v_add_f32 v49, v50, v51
  ds_write_b64 v59, v[48:49] offset:12288
  s_waitcnt lgkmcnt(1)
  s_add_u32 m0, s49, 6144
  s_add_u32 s45, s42, 224256
  buffer_load_dwordx4 v57, s[4:7], s45 offen lds
  s_add_u32 m0, s49, 7168
  s_add_u32 s45, s42, 297984
  buffer_load_dwordx4 v57, s[4:7], s45 offen lds
  s_waitcnt lgkmcnt(0)
  s_barrier
  v_mfma_f32_16x16x32_bf16 v[0:3], v[64:67], v[24:27], 0
  v_mfma_f32_16x16x32_bf16 v[4:7], v[76:79], v[28:31], 0
  v_mfma_f32_16x16x32_bf16 v[8:11], v[88:91], v[32:35], 0
  ds_read_b64 v[24:25], v60 offset:12288
  ds_read_b64 v[26:27], v60 offset:12544
  ds_read_b64 v[28:29], v60 offset:12800
  ds_read_b64 v[30:31], v60 offset:13056
  ds_read_b64 v[32:33], v60 offset:13312
  ds_read_b64 v[34:35], v60 offset:13568
  ds_read_b64 v[48:49], v60 offset:13824
  ds_read_b64 v[50:51], v60 offset:14080
  s_waitcnt lgkmcnt(0)
  v_pk_add_f32 v[24:25], v[24:25], v[32:33]
  v_pk_add_f32 v[26:27], v[26:27], v[34:35]
  v_pk_add_f32 v[28:29], v[28:29], v[48:49]
  v_pk_add_f32 v[30:31], v[30:31], v[50:51]
  v_pk_add_f32 v[24:25], v[24:25], v[28:29]
  v_pk_add_f32 v[26:27], v[26:27], v[30:31]
  v_pk_add_f32 v[24:25], v[24:25], v[26:27]
  v_pk_mul_f32 v[24:25], v[24:25], s[52:53]
  v_mfma_f32_16x16x32_bf16 v[0:3], v[68:71], v[36:39], v[0:3]
  v_fma_f32 v25, -v24, v24, v25
  v_max_f32 v25, s57, v25
  v_mfma_f32_16x16x32_bf16 v[4:7], v[80:83], v[40:43], v[4:7]
  v_rsq_f32 v25, v25
  v_mfma_f32_16x16x32_bf16 v[8:11], v[92:95], v[44:47], v[8:11]
  v_mul_f32 v52, s56, v25
  v_mul_f32 v53, -v24, v52
  v_pk_fma_f32 v[12:13], v[12:13], v[52:53], v[52:53] op_sel:[0,0,1] op_sel_hi:[1,0,1]
  v_pk_fma_f32 v[14:15], v[14:15], v[52:53], v[52:53] op_sel:[0,0,1] op_sel_hi:[1,0,1]
  v_pk_fma_f32 v[16:17], v[16:17], v[52:53], v[52:53] op_sel:[0,0,1] op_sel_hi:[1,0,1]
  v_pk_fma_f32 v[18:19], v[18:19], v[52:53], v[52:53] op_sel:[0,0,1] op_sel_hi:[1,0,1]
  v_pk_fma_f32 v[20:21], v[20:21], v[52:53], v[52:53] op_sel:[0,0,1] op_sel_hi:[1,0,1]
  v_pk_fma_f32 v[22:23], v[22:23], v[52:53], v[52:53] op_sel:[0,0,1] op_sel_hi:[1,0,1]
  v_mfma_f32_16x16x32_bf16 v[0:3], v[72:75], v[100:103], v[0:3]
  v_cvt_pk_bf16_f32 v12, v12, v13
  v_cvt_pk_bf16_f32 v13, v14, v15
  v_mfma_f32_16x16x32_bf16 v[4:7], v[84:87], v[104:107], v[4:7]
  v_cvt_pk_bf16_f32 v14, v16, v17
  v_cvt_pk_bf16_f32 v15, v18, v19
  v_mfma_f32_16x16x32_bf16 v[8:11], v[96:99], v[108:111], v[8:11]
  v_cvt_pk_bf16_f32 v16, v20, v21
  v_cvt_pk_bf16_f32 v17, v22, v23
  ds_write_b64 v61, v[12:13] offset:6656
  ds_write_b64 v61, v[14:15] offset:6672
  ds_write_b64 v61, v[16:17] offset:6688
  s_waitcnt vmcnt(10)
  ds_read_b128 v[24:27], v55 offset:0
  ds_read_b128 v[28:31], v55 offset:16
  ds_read_b128 v[32:35], v55 offset:32
  ds_read_b128 v[36:39], v55 offset:48
  ds_read_b128 v[40:43], v55 offset:64
  ds_read_b128 v[44:47], v55 offset:80
  ds_read_b128 v[100:103], v55 offset:96
  ds_read_b128 v[104:107], v55 offset:112
  ds_read_b128 v[108:111], v55 offset:128
  s_cmp_ge_u32 s2, 72
  s_cbranch_scc1 L_HW0
  s_cmp_lg_u32 s41, 3
  s_cbranch_scc1 L_HW0
  s_mul_i32 s45, s2, 43
  s_lshr_b32 s45, s45, 10
  s_mul_i32 s46, s45, 24
  s_sub_u32 s46, s2, s46
  s_lshl_b32 s45, s45, 6
  s_and_b32 s48, s46, 1
  s_lshl_b32 s48, s48, 3
  s_add_u32 s45, s45, s48
  s_lshr_b32 s46, s46, 1
  s_mul_i32 s46, s46, 6144
  s_add_u32 s45, s45, s46
  buffer_load_ushort v216, v212, s[20:23], s45 offen offset:0
  buffer_load_ushort v217, v212, s[20:23], s45 offen offset:192
  buffer_load_ushort v218, v212, s[20:23], s45 offen offset:384
  buffer_load_ushort v219, v212, s[20:23], s45 offen offset:576
  buffer_load_ushort v220, v212, s[20:23], s45 offen offset:768
  buffer_load_ushort v221, v212, s[20:23], s45 offen offset:960
  buffer_load_ushort v222, v212, s[20:23], s45 offen offset:1152
  buffer_load_ushort v223, v212, s[20:23], s45 offen offset:1344
  s_mul_i32 s46, s2, 43
  s_lshr_b32 s46, s46, 10
  s_mul_i32 s46, s46, 24
  s_sub_u32 s46, s2, s46
  s_lshr_b32 s46, s46, 1
  s_lshl_b32 s46, s46, 6
  buffer_load_dwordx4 v[236:239], v244, s[32:35], s46 offen
L_HW0:
  v_pk_add_f32 v[48:49], v[0:1], v[2:3]
  v_pk_fma_f32 v[50:51], v[0:1], v[0:1], s[54:55]
  v_pk_fma_f32 v[50:51], v[2:3], v[2:3], v[50:51]
  v_pk_add_f32 v[48:49], v[48:49], v[4:5]
  v_pk_fma_f32 v[50:51], v[4:5], v[4:5], v[50:51]
  v_pk_add_f32 v[48:49], v[48:49], v[6:7]
  v_pk_fma_f32 v[50:51], v[6:7], v[6:7], v[50:51]
  v_pk_add_f32 v[48:49], v[48:49], v[8:9]
  v_pk_fma_f32 v[50:51], v[8:9], v[8:9], v[50:51]
  v_pk_add_f32 v[48:49], v[48:49], v[10:11]
  v_pk_fma_f32 v[50:51], v[10:11], v[10:11], v[50:51]
  v_add_f32 v48, v48, v49
  v_add_f32 v49, v50, v51
  ds_write_b64 v59, v[48:49] offset:0
  s_waitcnt lgkmcnt(1)
  s_add_u32 m0, s49, 8192
  s_add_u32 s45, s42, 371712
  buffer_load_dwordx4 v57, s[4:7], s45 offen lds
  s_add_u32 m0, s49, 9216
  s_add_u32 s45, s42, 445440
  buffer_load_dwordx4 v57, s[4:7], s45 offen lds
  s_add_u32 m0, s49, 0
  s_add_u32 s45, s42, 519168
  buffer_load_dwordx4 v57, s[4:7], s45 offen lds
  s_add_u32 m0, s49, 1024
  s_add_u32 s45, s42, 592896
  buffer_load_dwordx4 v57, s[4:7], s45 offen lds
  s_waitcnt lgkmcnt(0)
  s_barrier
  v_mfma_f32_16x16x32_bf16 v[12:15], v[64:67], v[24:27], 0
  v_mfma_f32_16x16x32_bf16 v[16:19], v[76:79], v[28:31], 0
  v_mfma_f32_16x16x32_bf16 v[20:23], v[88:91], v[32:35], 0
  ds_read_b64 v[24:25], v60 offset:0
  ds_read_b64 v[26:27], v60 offset:256
  ds_read_b64 v[28:29], v60 offset:512
  ds_read_b64 v[30:31], v60 offset:768
  ds_read_b64 v[32:33], v60 offset:1024
  ds_read_b64 v[34:35], v60 offset:1280
  ds_read_b64 v[48:49], v60 offset:1536
  ds_read_b64 v[50:51], v60 offset:1792
  s_waitcnt lgkmcnt(0)
  v_pk_add_f32 v[24:25], v[24:25], v[32:33]
  v_pk_add_f32 v[26:27], v[26:27], v[34:35]
  v_pk_add_f32 v[28:29], v[28:29], v[48:49]
  v_pk_add_f32 v[30:31], v[30:31], v[50:51]
  v_pk_add_f32 v[24:25], v[24:25], v[28:29]
  v_pk_add_f32 v[26:27], v[26:27], v[30:31]
  v_pk_add_f32 v[24:25], v[24:25], v[26:27]
  v_pk_mul_f32 v[24:25], v[24:25], s[52:53]
  v_mfma_f32_16x16x32_bf16 v[12:15], v[68:71], v[36:39], v[12:15]
  v_fma_f32 v25, -v24, v24, v25
  v_max_f32 v25, s57, v25
  v_mfma_f32_16x16x32_bf16 v[16:19], v[80:83], v[40:43], v[16:19]
  v_rsq_f32 v25, v25
  v_mfma_f32_16x16x32_bf16 v[20:23], v[92:95], v[44:47], v[20:23]
  v_mul_f32 v52, s56, v25
  v_mul_f32 v53, -v24, v52
  v_pk_fma_f32 v[0:1], v[0:1], v[52:53], v[52:53] op_sel:[0,0,1] op_sel_hi:[1,0,1]
  v_pk_fma_f32 v[2:3], v[2:3], v[52:53], v[52:53] op_sel:[0,0,1] op_sel_hi:[1,0,1]
  v_pk_fma_f32 v[4:5], v[4:5], v[52:53], v[52:53] op_sel:[0,0,1] op_sel_hi:[1,0,1]
  v_pk_fma_f32 v[6:7], v[6:7], v[52:53], v[52:53] op_sel:[0,0,1] op_sel_hi:[1,0,1]
  v_pk_fma_f32 v[8:9], v[8:9], v[52:53], v[52:53] op_sel:[0,0,1] op_sel_hi:[1,0,1]
  v_pk_fma_f32 v[10:11], v[10:11], v[52:53], v[52:53] op_sel:[0,0,1] op_sel_hi:[1,0,1]
  v_mfma_f32_16x16x32_bf16 v[12:15], v[72:75], v[100:103], v[12:15]
  v_cvt_pk_bf16_f32 v0, v0, v1
  v_cvt_pk_bf16_f32 v1, v2, v3
  v_mfma_f32_16x16x32_bf16 v[16:19], v[84:87], v[104:107], v[16:19]
  v_cvt_pk_bf16_f32 v2, v4, v5
  v_cvt_pk_bf16_f32 v3, v6, v7
  v_mfma_f32_16x16x32_bf16 v[20:23], v[96:99], v[108:111], v[20:23]
  v_cvt_pk_bf16_f32 v4, v8, v9
  v_cvt_pk_bf16_f32 v5, v10, v11
  ds_write_b64 v61, v[0:1] offset:0
  ds_write_b64 v61, v[2:3] offset:16
  ds_write_b64 v61, v[4:5] offset:32
  s_waitcnt vmcnt(10)
  ds_read_b128 v[24:27], v54 offset:2048
  ds_read_b128 v[28:31], v54 offset:2064
  ds_read_b128 v[32:35], v54 offset:2080
  ds_read_b128 v[36:39], v54 offset:2096
  ds_read_b128 v[40:43], v54 offset:2112
  ds_read_b128 v[44:47], v54 offset:2128
  ds_read_b128 v[100:103], v54 offset:2144
  ds_read_b128 v[104:107], v54 offset:2160
  ds_read_b128 v[108:111], v54 offset:2176
  ds_read_b64_tr_b16 v[112:113], v62 offset:0
  ds_read_b64_tr_b16 v[114:115], v63 offset:0
  ds_read_b64_tr_b16 v[116:117], v62 offset:2048
  ds_read_b64_tr_b16 v[118:119], v63 offset:2048
  ds_read_b64_tr_b16 v[120:121], v62 offset:4096
  ds_read_b64_tr_b16 v[122:123], v63 offset:4096
  ds_read_b64_tr_b16 v[124:125], v62 offset:6144
  ds_read_b64_tr_b16 v[126:127], v63 offset:6144
  ds_read_b64_tr_b16 v[128:129], v62 offset:8192
  ds_read_b64_tr_b16 v[130:131], v63 offset:8192
  ds_read_b64_tr_b16 v[132:133], v62 offset:10240
  ds_read_b64_tr_b16 v[134:135], v63 offset:10240
  ds_read_b64_tr_b16 v[136:137], v62 offset:12288
  ds_read_b64_tr_b16 v[138:139], v63 offset:12288
  ds_read_b64_tr_b16 v[140:141], v62 offset:14336
  ds_read_b64_tr_b16 v[142:143], v63 offset:14336
  ds_read_b64_tr_b16 v[144:145], v62 offset:16384
  ds_read_b64_tr_b16 v[146:147], v63 offset:16384
  ds_read_b64_tr_b16 v[148:149], v62 offset:18432
  ds_read_b64_tr_b16 v[150:151], v63 offset:18432
  ds_read_b64_tr_b16 v[152:153], v62 offset:20480
  ds_read_b64_tr_b16 v[154:155], v63 offset:20480
  ds_read_b64_tr_b16 v[156:157], v62 offset:22528
  ds_read_b64_tr_b16 v[158:159], v63 offset:22528
  v_add_u32 v62, 49152, v62
  v_add_u32 v63, 49152, v63
  v_pk_add_f32 v[48:49], v[12:13], v[14:15]
  v_pk_fma_f32 v[50:51], v[12:13], v[12:13], s[54:55]
  v_pk_fma_f32 v[50:51], v[14:15], v[14:15], v[50:51]
  v_pk_add_f32 v[48:49], v[48:49], v[16:17]
  v_pk_fma_f32 v[50:51], v[16:17], v[16:17], v[50:51]
  v_pk_add_f32 v[48:49], v[48:49], v[18:19]
  v_pk_fma_f32 v[50:51], v[18:19], v[18:19], v[50:51]
  v_pk_add_f32 v[48:49], v[48:49], v[20:21]
  v_pk_fma_f32 v[50:51], v[20:21], v[20:21], v[50:51]
  v_pk_add_f32 v[48:49], v[48:49], v[22:23]
  v_pk_fma_f32 v[50:51], v[22:23], v[22:23], v[50:51]
  v_add_f32 v48, v48, v49
  v_add_f32 v49, v50, v51
  ds_write_b64 v59, v[48:49] offset:12288
  s_waitcnt lgkmcnt(1)
  s_add_u32 m0, s49, 2048
  s_add_u32 s45, s42, 666624
  buffer_load_dwordx4 v57, s[4:7], s45 offen lds
  s_add_u32 m0, s49, 3072
  s_add_u32 s45, s42, 740352
  buffer_load_dwordx4 v57, s[4:7], s45 offen lds
  s_waitcnt vmcnt(8)
  s_waitcnt lgkmcnt(0)
  s_barrier
  v_mfma_f32_16x16x32_bf16 v[0:3], v[64:67], v[24:27], 0
  v_mfma_f32_16x16x32_bf16 v[4:7], v[76:79], v[28:31], 0
  v_mfma_f32_16x16x32_bf16 v[8:11], v[88:91], v[32:35], 0
  ds_read_b64 v[24:25], v60 offset:12288
  ds_read_b64 v[26:27], v60 offset:12544
  ds_read_b64 v[28:29], v60 offset:12800
  ds_read_b64 v[30:31], v60 offset:13056
  ds_read_b64 v[32:33], v60 offset:13312
  ds_read_b64 v[34:35], v60 offset:13568
  ds_read_b64 v[48:49], v60 offset:13824
  ds_read_b64 v[50:51], v60 offset:14080
  s_waitcnt lgkmcnt(0)
  v_pk_add_f32 v[24:25], v[24:25], v[32:33]
  v_pk_add_f32 v[26:27], v[26:27], v[34:35]
  v_pk_add_f32 v[28:29], v[28:29], v[48:49]
  v_pk_add_f32 v[30:31], v[30:31], v[50:51]
  v_pk_add_f32 v[24:25], v[24:25], v[28:29]
  v_pk_add_f32 v[26:27], v[26:27], v[30:31]
  v_pk_add_f32 v[24:25], v[24:25], v[26:27]
  v_pk_mul_f32 v[24:25], v[24:25], s[52:53]
  v_mfma_f32_16x16x32_bf16 v[0:3], v[68:71], v[36:39], v[0:3]
  v_fma_f32 v25, -v24, v24, v25
  v_max_f32 v25, s57, v25
  v_mfma_f32_16x16x32_bf16 v[4:7], v[80:83], v[40:43], v[4:7]
  v_rsq_f32 v25, v25
  v_mfma_f32_16x16x32_bf16 v[8:11], v[92:95], v[44:47], v[8:11]
  v_mul_f32 v52, s56, v25
  v_mul_f32 v53, -v24, v52
  v_pk_fma_f32 v[12:13], v[12:13], v[52:53], v[52:53] op_sel:[0,0,1] op_sel_hi:[1,0,1]
  v_pk_fma_f32 v[14:15], v[14:15], v[52:53], v[52:53] op_sel:[0,0,1] op_sel_hi:[1,0,1]
  v_pk_fma_f32 v[16:17], v[16:17], v[52:53], v[52:53] op_sel:[0,0,1] op_sel_hi:[1,0,1]
  v_pk_fma_f32 v[18:19], v[18:19], v[52:53], v[52:53] op_sel:[0,0,1] op_sel_hi:[1,0,1]
  v_pk_fma_f32 v[20:21], v[20:21], v[52:53], v[52:53] op_sel:[0,0,1] op_sel_hi:[1,0,1]
  v_pk_fma_f32 v[22:23], v[22:23], v[52:53], v[52:53] op_sel:[0,0,1] op_sel_hi:[1,0,1]
  v_mfma_f32_16x16x32_bf16 v[0:3], v[72:75], v[100:103], v[0:3]
  v_cvt_pk_bf16_f32 v12, v12, v13
  v_cvt_pk_bf16_f32 v13, v14, v15
  v_mfma_f32_16x16x32_bf16 v[4:7], v[84:87], v[104:107], v[4:7]
  v_cvt_pk_bf16_f32 v14, v16, v17
  v_cvt_pk_bf16_f32 v15, v18, v19
  v_mfma_f32_16x16x32_bf16 v[8:11], v[96:99], v[108:111], v[8:11]
  v_cvt_pk_bf16_f32 v16, v20, v21
  v_cvt_pk_bf16_f32 v17, v22, v23
  ds_write_b64 v61, v[12:13] offset:6656
  ds_write_b64 v61, v[14:15] offset:6672
  ds_write_b64 v61, v[16:17] offset:6688
  s_waitcnt vmcnt(6)
  ds_read_b128 v[24:27], v54 offset:4096
  ds_read_b128 v[28:31], v54 offset:4112
  ds_read_b128 v[32:35], v54 offset:4128
  ds_read_b128 v[36:39], v54 offset:4144
  ds_read_b128 v[40:43], v54 offset:4160
  ds_read_b128 v[44:47], v54 offset:4176
  ds_read_b128 v[100:103], v54 offset:4192
  ds_read_b128 v[104:107], v54 offset:4208
  ds_read_b128 v[108:111], v54 offset:4224
  s_cmp_ge_u32 s2, 72
  s_cbranch_scc1 L_HW1
  s_cmp_lg_u32 s41, 3
  s_cbranch_scc1 L_HW1
  s_waitcnt vmcnt(6)
  v_lshl_or_b32 v208, v217, 16, v216
  v_lshl_or_b32 v209, v219, 16, v218
  v_lshl_or_b32 v210, v221, 16, v220
  v_lshl_or_b32 v211, v223, 16, v222
  s_lshl_b32 s45, s2, 10
  s_add_u32 s45, s45, 524288
  buffer_store_dwordx4 v[208:211], v213, s[12:15], s45 offen sc1
  v_mfma_f32_16x16x32_bf16 v[240:243], v[208:211], v[236:239], 0
  s_mul_i32 s45, s2, 43
  s_lshr_b32 s45, s45, 10
  s_mul_i32 s46, s45, 24
  s_sub_u32 s46, s2, s46
  s_lshl_b32 s45, s45, 7
  s_and_b32 s48, s46, 1
  s_lshl_b32 s48, s48, 4
  s_add_u32 s45, s45, s48
  s_lshr_b32 s46, s46, 1
  s_mul_i32 s46, s46, 384
  s_add_u32 s45, s45, s46
  s_add_u32 s45, s45, 622592
  buffer_store_dwordx4 v[240:243], v245, s[12:15], s45 offen sc1
L_HW1:
  s_cmp_lg_u32 s41, 0
  s_cbranch_scc1 L_HC
  buffer_atomic_add v215, v214, s[36:39], 0 offen sc1
L_HC:
  v_pk_add_f32 v[48:49], v[0:1], v[2:3]
  v_pk_fma_f32 v[50:51], v[0:1], v[0:1], s[54:55]
  v_pk_fma_f32 v[50:51], v[2:3], v[2:3], v[50:51]
  v_pk_add_f32 v[48:49], v[48:49], v[4:5]
  v_pk_fma_f32 v[50:51], v[4:5], v[4:5], v[50:51]
  v_pk_add_f32 v[48:49], v[48:49], v[6:7]
  v_pk_fma_f32 v[50:51], v[6:7], v[6:7], v[50:51]
  v_pk_add_f32 v[48:49], v[48:49], v[8:9]
  v_pk_fma_f32 v[50:51], v[8:9], v[8:9], v[50:51]
  v_pk_add_f32 v[48:49], v[48:49], v[10:11]
  v_pk_fma_f32 v[50:51], v[10:11], v[10:11], v[50:51]
  v_add_f32 v48, v48, v49
  v_add_f32 v49, v50, v51
  ds_write_b64 v59, v[48:49] offset:0
  s_waitcnt lgkmcnt(1)
  s_add_u32 m0, s49, 4096
  s_add_u32 s45, s42, 814080
  buffer_load_dwordx4 v57, s[4:7], s45 offen lds
  s_add_u32 m0, s49, 5120
  s_add_u32 s45, s44, 3072
  buffer_load_dwordx4 v57, s[4:7], s45 offen lds
  s_waitcnt lgkmcnt(0)
  s_barrier
  v_mfma_f32_16x16x32_bf16 v[12:15], v[64:67], v[24:27], 0
  v_mfma_f32_16x16x32_bf16 v[16:19], v[76:79], v[28:31], 0
  v_mfma_f32_16x16x32_bf16 v[20:23], v[88:91], v[32:35], 0
  ds_read_b64 v[24:25], v60 offset:0
  ds_read_b64 v[26:27], v60 offset:256
  ds_read_b64 v[28:29], v60 offset:512
  ds_read_b64 v[30:31], v60 offset:768
  ds_read_b64 v[32:33], v60 offset:1024
  ds_read_b64 v[34:35], v60 offset:1280
  ds_read_b64 v[48:49], v60 offset:1536
  ds_read_b64 v[50:51], v60 offset:1792
  s_waitcnt lgkmcnt(0)
  v_pk_add_f32 v[24:25], v[24:25], v[32:33]
  v_pk_add_f32 v[26:27], v[26:27], v[34:35]
  v_pk_add_f32 v[28:29], v[28:29], v[48:49]
  v_pk_add_f32 v[30:31], v[30:31], v[50:51]
  v_pk_add_f32 v[24:25], v[24:25], v[28:29]
  v_pk_add_f32 v[26:27], v[26:27], v[30:31]
  v_pk_add_f32 v[24:25], v[24:25], v[26:27]
  v_pk_mul_f32 v[24:25], v[24:25], s[52:53]
  v_mfma_f32_16x16x32_bf16 v[12:15], v[68:71], v[36:39], v[12:15]
  v_fma_f32 v25, -v24, v24, v25
  v_max_f32 v25, s57, v25
  v_mfma_f32_16x16x32_bf16 v[16:19], v[80:83], v[40:43], v[16:19]
  v_rsq_f32 v25, v25
  v_mfma_f32_16x16x32_bf16 v[20:23], v[92:95], v[44:47], v[20:23]
  v_mul_f32 v52, s56, v25
  v_mul_f32 v53, -v24, v52
  v_pk_fma_f32 v[0:1], v[0:1], v[52:53], v[52:53] op_sel:[0,0,1] op_sel_hi:[1,0,1]
  v_pk_fma_f32 v[2:3], v[2:3], v[52:53], v[52:53] op_sel:[0,0,1] op_sel_hi:[1,0,1]
  v_pk_fma_f32 v[4:5], v[4:5], v[52:53], v[52:53] op_sel:[0,0,1] op_sel_hi:[1,0,1]
  v_pk_fma_f32 v[6:7], v[6:7], v[52:53], v[52:53] op_sel:[0,0,1] op_sel_hi:[1,0,1]
  v_pk_fma_f32 v[8:9], v[8:9], v[52:53], v[52:53] op_sel:[0,0,1] op_sel_hi:[1,0,1]
  v_pk_fma_f32 v[10:11], v[10:11], v[52:53], v[52:53] op_sel:[0,0,1] op_sel_hi:[1,0,1]
  v_mfma_f32_16x16x32_bf16 v[12:15], v[72:75], v[100:103], v[12:15]
  v_cvt_pk_bf16_f32 v0, v0, v1
  v_cvt_pk_bf16_f32 v1, v2, v3
  v_mfma_f32_16x16x32_bf16 v[16:19], v[84:87], v[104:107], v[16:19]
  v_cvt_pk_bf16_f32 v2, v4, v5
  v_cvt_pk_bf16_f32 v3, v6, v7
  v_mfma_f32_16x16x32_bf16 v[20:23], v[96:99], v[108:111], v[20:23]
  v_cvt_pk_bf16_f32 v4, v8, v9
  v_cvt_pk_bf16_f32 v5, v10, v11
  ds_write_b64 v61, v[0:1] offset:0
  ds_write_b64 v61, v[2:3] offset:16
  ds_write_b64 v61, v[4:5] offset:32
  s_waitcnt vmcnt(6)
  ds_read_b128 v[24:27], v54 offset:6144
  ds_read_b128 v[28:31], v54 offset:6160
  ds_read_b128 v[32:35], v54 offset:6176
  ds_read_b128 v[36:39], v54 offset:6192
  ds_read_b128 v[40:43], v54 offset:6208
  ds_read_b128 v[44:47], v54 offset:6224
  ds_read_b128 v[100:103], v54 offset:6240
  ds_read_b128 v[104:107], v54 offset:6256
  ds_read_b128 v[108:111], v54 offset:6272
  ds_read_b64_tr_b16 v[160:161], v62 offset:0
  ds_read_b64_tr_b16 v[162:163], v63 offset:0
  ds_read_b64_tr_b16 v[164:165], v62 offset:2048
  ds_read_b64_tr_b16 v[166:167], v63 offset:2048
  ds_read_b64_tr_b16 v[168:169], v62 offset:4096
  ds_read_b64_tr_b16 v[170:171], v63 offset:4096
  ds_read_b64_tr_b16 v[172:173], v62 offset:6144
  ds_read_b64_tr_b16 v[174:175], v63 offset:6144
  ds_read_b64_tr_b16 v[176:177], v62 offset:8192
  ds_read_b64_tr_b16 v[178:179], v63 offset:8192
  ds_read_b64_tr_b16 v[180:181], v62 offset:10240
  ds_read_b64_tr_b16 v[182:183], v63 offset:10240
  ds_read_b64_tr_b16 v[184:185], v62 offset:12288
  ds_read_b64_tr_b16 v[186:187], v63 offset:12288
  ds_read_b64_tr_b16 v[188:189], v62 offset:14336
  ds_read_b64_tr_b16 v[190:191], v63 offset:14336
  ds_read_b64_tr_b16 v[192:193], v62 offset:16384
  ds_read_b64_tr_b16 v[194:195], v63 offset:16384
  ds_read_b64_tr_b16 v[196:197], v62 offset:18432
  ds_read_b64_tr_b16 v[198:199], v63 offset:18432
  ds_read_b64_tr_b16 v[200:201], v62 offset:20480
  ds_read_b64_tr_b16 v[202:203], v63 offset:20480
  ds_read_b64_tr_b16 v[204:205], v62 offset:22528
  ds_read_b64_tr_b16 v[206:207], v63 offset:22528
  v_subrev_u32 v62, 49152, v62
  v_subrev_u32 v63, 49152, v63
  v_pk_add_f32 v[48:49], v[12:13], v[14:15]
  v_pk_fma_f32 v[50:51], v[12:13], v[12:13], s[54:55]
  v_pk_fma_f32 v[50:51], v[14:15], v[14:15], v[50:51]
  v_pk_add_f32 v[48:49], v[48:49], v[16:17]
  v_pk_fma_f32 v[50:51], v[16:17], v[16:17], v[50:51]
  v_pk_add_f32 v[48:49], v[48:49], v[18:19]
  v_pk_fma_f32 v[50:51], v[18:19], v[18:19], v[50:51]
  v_pk_add_f32 v[48:49], v[48:49], v[20:21]
  v_pk_fma_f32 v[50:51], v[20:21], v[20:21], v[50:51]
  v_pk_add_f32 v[48:49], v[48:49], v[22:23]
  v_pk_fma_f32 v[50:51], v[22:23], v[22:23], v[50:51]
  v_add_f32 v48, v48, v49
  v_add_f32 v49, v50, v51
  ds_write_b64 v59, v[48:49] offset:12288
  s_waitcnt lgkmcnt(1)
  s_add_u32 m0, s49, 6144
  s_add_u32 s45, s43, 6144
  buffer_load_dwordx4 v58, s[4:7], s45 offen lds
  s_add_u32 m0, s49, 7168
  s_add_u32 s45, s42, 6144
  buffer_load_dwordx4 v58, s[4:7], s45 offen lds
  s_waitcnt lgkmcnt(0)
  s_barrier
  v_mfma_f32_16x16x32_bf16 v[0:3], v[64:67], v[24:27], 0
  v_mfma_f32_16x16x32_bf16 v[4:7], v[76:79], v[28:31], 0
  v_mfma_f32_16x16x32_bf16 v[8:11], v[88:91], v[32:35], 0
  ds_read_b64 v[24:25], v60 offset:12288
  ds_read_b64 v[26:27], v60 offset:12544
  ds_read_b64 v[28:29], v60 offset:12800
  ds_read_b64 v[30:31], v60 offset:13056
  ds_read_b64 v[32:33], v60 offset:13312
  ds_read_b64 v[34:35], v60 offset:13568
  ds_read_b64 v[48:49], v60 offset:13824
  ds_read_b64 v[50:51], v60 offset:14080
  s_waitcnt lgkmcnt(0)
  v_pk_add_f32 v[24:25], v[24:25], v[32:33]
  v_pk_add_f32 v[26:27], v[26:27], v[34:35]
  v_pk_add_f32 v[28:29], v[28:29], v[48:49]
  v_pk_add_f32 v[30:31], v[30:31], v[50:51]
  v_pk_add_f32 v[24:25], v[24:25], v[28:29]
  v_pk_add_f32 v[26:27], v[26:27], v[30:31]
  v_pk_add_f32 v[24:25], v[24:25], v[26:27]
  v_pk_mul_f32 v[24:25], v[24:25], s[52:53]
  v_mfma_f32_16x16x32_bf16 v[0:3], v[68:71], v[36:39], v[0:3]
  v_fma_f32 v25, -v24, v24, v25
  v_max_f32 v25, s57, v25
  v_mfma_f32_16x16x32_bf16 v[4:7], v[80:83], v[40:43], v[4:7]
  v_rsq_f32 v25, v25
  v_mfma_f32_16x16x32_bf16 v[8:11], v[92:95], v[44:47], v[8:11]
  v_mul_f32 v52, s56, v25
  v_mul_f32 v53, -v24, v52
  v_pk_fma_f32 v[12:13], v[12:13], v[52:53], v[52:53] op_sel:[0,0,1] op_sel_hi:[1,0,1]
  v_pk_fma_f32 v[14:15], v[14:15], v[52:53], v[52:53] op_sel:[0,0,1] op_sel_hi:[1,0,1]
  v_pk_fma_f32 v[16:17], v[16:17], v[52:53], v[52:53] op_sel:[0,0,1] op_sel_hi:[1,0,1]
  v_pk_fma_f32 v[18:19], v[18:19], v[52:53], v[52:53] op_sel:[0,0,1] op_sel_hi:[1,0,1]
  v_pk_fma_f32 v[20:21], v[20:21], v[52:53], v[52:53] op_sel:[0,0,1] op_sel_hi:[1,0,1]
  v_pk_fma_f32 v[22:23], v[22:23], v[52:53], v[52:53] op_sel:[0,0,1] op_sel_hi:[1,0,1]
  v_mfma_f32_16x16x32_bf16 v[0:3], v[72:75], v[100:103], v[0:3]
  v_cvt_pk_bf16_f32 v12, v12, v13
  v_cvt_pk_bf16_f32 v13, v14, v15
  v_mfma_f32_16x16x32_bf16 v[4:7], v[84:87], v[104:107], v[4:7]
  v_cvt_pk_bf16_f32 v14, v16, v17
  v_cvt_pk_bf16_f32 v15, v18, v19
  v_mfma_f32_16x16x32_bf16 v[8:11], v[96:99], v[108:111], v[8:11]
  v_cvt_pk_bf16_f32 v16, v20, v21
  v_cvt_pk_bf16_f32 v17, v22, v23
  ds_write_b64 v61, v[12:13] offset:6656
  ds_write_b64 v61, v[14:15] offset:6672
  ds_write_b64 v61, v[16:17] offset:6688
  s_waitcnt vmcnt(6)
  ds_read_b128 v[24:27], v55 offset:0
  ds_read_b128 v[28:31], v55 offset:16
  ds_read_b128 v[32:35], v55 offset:32
  ds_read_b128 v[36:39], v55 offset:48
  ds_read_b128 v[40:43], v55 offset:64
  ds_read_b128 v[44:47], v55 offset:80
  ds_read_b128 v[100:103], v55 offset:96
  ds_read_b128 v[104:107], v55 offset:112
  ds_read_b128 v[108:111], v55 offset:128
  s_cmp_ge_u32 s2, 72
  s_cbranch_scc1 L_HW2
  s_cmp_lg_u32 s41, 3
  s_cbranch_scc1 L_HW2
  s_waitcnt vmcnt(4)
  buffer_atomic_add v215, v214, s[36:39], 0 offen sc1
L_HW2:
  v_pk_add_f32 v[48:49], v[0:1], v[2:3]
  v_pk_fma_f32 v[50:51], v[0:1], v[0:1], s[54:55]
  v_pk_fma_f32 v[50:51], v[2:3], v[2:3], v[50:51]
  v_pk_add_f32 v[48:49], v[48:49], v[4:5]
  v_pk_fma_f32 v[50:51], v[4:5], v[4:5], v[50:51]
  v_pk_add_f32 v[48:49], v[48:49], v[6:7]
  v_pk_fma_f32 v[50:51], v[6:7], v[6:7], v[50:51]
  v_pk_add_f32 v[48:49], v[48:49], v[8:9]
  v_pk_fma_f32 v[50:51], v[8:9], v[8:9], v[50:51]
  v_pk_add_f32 v[48:49], v[48:49], v[10:11]
  v_pk_fma_f32 v[50:51], v[10:11], v[10:11], v[50:51]
  v_add_f32 v48, v48, v49
  v_add_f32 v49, v50, v51
  ds_write_b64 v59, v[48:49] offset:0
  s_waitcnt lgkmcnt(1)
  s_add_u32 m0, s49, 8192
  s_add_u32 s45, s42, 79872
  buffer_load_dwordx4 v58, s[4:7], s45 offen lds
  s_add_u32 m0, s49, 9216
  s_add_u32 s45, s42, 153600
  buffer_load_dwordx4 v58, s[4:7], s45 offen lds
  s_waitcnt lgkmcnt(0)
  s_barrier
  v_mfma_f32_16x16x32_bf16 v[12:15], v[64:67], v[24:27], 0
  v_mfma_f32_16x16x32_bf16 v[16:19], v[76:79], v[28:31], 0
  v_mfma_f32_16x16x32_bf16 v[20:23], v[88:91], v[32:35], 0
  ds_read_b64 v[24:25], v60 offset:0
  ds_read_b64 v[26:27], v60 offset:256
  ds_read_b64 v[28:29], v60 offset:512
  ds_read_b64 v[30:31], v60 offset:768
  ds_read_b64 v[32:33], v60 offset:1024
  ds_read_b64 v[34:35], v60 offset:1280
  ds_read_b64 v[48:49], v60 offset:1536
  ds_read_b64 v[50:51], v60 offset:1792
  s_waitcnt lgkmcnt(0)
  v_pk_add_f32 v[24:25], v[24:25], v[32:33]
  v_pk_add_f32 v[26:27], v[26:27], v[34:35]
  v_pk_add_f32 v[28:29], v[28:29], v[48:49]
  v_pk_add_f32 v[30:31], v[30:31], v[50:51]
  v_pk_add_f32 v[24:25], v[24:25], v[28:29]
  v_pk_add_f32 v[26:27], v[26:27], v[30:31]
  v_pk_add_f32 v[24:25], v[24:25], v[26:27]
  v_pk_mul_f32 v[24:25], v[24:25], s[52:53]
  v_mfma_f32_16x16x32_bf16 v[12:15], v[68:71], v[36:39], v[12:15]
  v_fma_f32 v25, -v24, v24, v25
  v_max_f32 v25, s57, v25
  v_mfma_f32_16x16x32_bf16 v[16:19], v[80:83], v[40:43], v[16:19]
  v_rsq_f32 v25, v25
  v_mfma_f32_16x16x32_bf16 v[20:23], v[92:95], v[44:47], v[20:23]
  v_mul_f32 v52, s56, v25
  v_mul_f32 v53, -v24, v52
  v_pk_fma_f32 v[0:1], v[0:1], v[52:53], v[52:53] op_sel:[0,0,1] op_sel_hi:[1,0,1]
  v_pk_fma_f32 v[2:3], v[2:3], v[52:53], v[52:53] op_sel:[0,0,1] op_sel_hi:[1,0,1]
  v_pk_fma_f32 v[4:5], v[4:5], v[52:53], v[52:53] op_sel:[0,0,1] op_sel_hi:[1,0,1]
  v_pk_fma_f32 v[6:7], v[6:7], v[52:53], v[52:53] op_sel:[0,0,1] op_sel_hi:[1,0,1]
  v_pk_fma_f32 v[8:9], v[8:9], v[52:53], v[52:53] op_sel:[0,0,1] op_sel_hi:[1,0,1]
  v_pk_fma_f32 v[10:11], v[10:11], v[52:53], v[52:53] op_sel:[0,0,1] op_sel_hi:[1,0,1]
  v_mfma_f32_16x16x32_bf16 v[12:15], v[72:75], v[100:103], v[12:15]
  v_cvt_pk_bf16_f32 v0, v0, v1
  v_cvt_pk_bf16_f32 v1, v2, v3
  v_mfma_f32_16x16x32_bf16 v[16:19], v[84:87], v[104:107], v[16:19]
  v_cvt_pk_bf16_f32 v2, v4, v5
  v_cvt_pk_bf16_f32 v3, v6, v7
  v_mfma_f32_16x16x32_bf16 v[20:23], v[96:99], v[108:111], v[20:23]
  v_cvt_pk_bf16_f32 v4, v8, v9
  v_cvt_pk_bf16_f32 v5, v10, v11
  ds_write_b64 v61, v[0:1] offset:0
  ds_write_b64 v61, v[2:3] offset:16
  ds_write_b64 v61, v[4:5] offset:32
  s_waitcnt vmcnt(6)
  ds_read_b128 v[24:27], v54 offset:0
  ds_read_b128 v[28:31], v54 offset:16
  ds_read_b128 v[32:35], v54 offset:32
  ds_read_b128 v[36:39], v54 offset:48
  ds_read_b128 v[40:43], v54 offset:64
  ds_read_b128 v[44:47], v54 offset:80
  ds_read_b128 v[100:103], v54 offset:96
  ds_read_b128 v[104:107], v54 offset:112
  ds_read_b128 v[108:111], v54 offset:128
  ds_read_b64_tr_b16 v[208:209], v62 offset:0
  ds_read_b64_tr_b16 v[210:211], v63 offset:0
  ds_read_b64_tr_b16 v[212:213], v62 offset:2048
  ds_read_b64_tr_b16 v[214:215], v63 offset:2048
  ds_read_b64_tr_b16 v[216:217], v62 offset:4096
  ds_read_b64_tr_b16 v[218:219], v63 offset:4096
  ds_read_b64_tr_b16 v[220:221], v62 offset:6144
  ds_read_b64_tr_b16 v[222:223], v63 offset:6144
  ds_read_b64_tr_b16 v[224:225], v62 offset:8192
  ds_read_b64_tr_b16 v[226:227], v63 offset:8192
  ds_read_b64_tr_b16 v[228:229], v62 offset:10240
  ds_read_b64_tr_b16 v[230:231], v63 offset:10240
  ds_read_b64_tr_b16 v[232:233], v62 offset:12288
  ds_read_b64_tr_b16 v[234:235], v63 offset:12288
  ds_read_b64_tr_b16 v[236:237], v62 offset:14336
  ds_read_b64_tr_b16 v[238:239], v63 offset:14336
  ds_read_b64_tr_b16 v[240:241], v62 offset:16384
  ds_read_b64_tr_b16 v[242:243], v63 offset:16384
  ds_read_b64_tr_b16 v[244:245], v62 offset:18432
  ds_read_b64_tr_b16 v[246:247], v63 offset:18432
  ds_read_b64_tr_b16 v[248:249], v62 offset:20480
  ds_read_b64_tr_b16 v[250:251], v63 offset:20480
  ds_read_b64_tr_b16 v[252:253], v62 offset:22528
  ds_read_b64_tr_b16 v[254:255], v63 offset:22528
  v_pk_add_f32 v[48:49], v[12:13], v[14:15]
  v_pk_fma_f32 v[50:51], v[12:13], v[12:13], s[54:55]
  v_pk_fma_f32 v[50:51], v[14:15], v[14:15], v[50:51]
  v_pk_add_f32 v[48:49], v[48:49], v[16:17]
  v_pk_fma_f32 v[50:51], v[16:17], v[16:17], v[50:51]
  v_pk_add_f32 v[48:49], v[48:49], v[18:19]
  v_pk_fma_f32 v[50:51], v[18:19], v[18:19], v[50:51]
  v_pk_add_f32 v[48:49], v[48:49], v[20:21]
  v_pk_fma_f32 v[50:51], v[20:21], v[20:21], v[50:51]
  v_pk_add_f32 v[48:49], v[48:49], v[22:23]
  v_pk_fma_f32 v[50:51], v[22:23], v[22:23], v[50:51]
  v_add_f32 v48, v48, v49
  v_add_f32 v49, v50, v51
  ds_write_b64 v59, v[48:49] offset:12288
  s_waitcnt lgkmcnt(1)
  s_add_u32 m0, s49, 0
  s_add_u32 s45, s42, 227328
  buffer_load_dwordx4 v58, s[4:7], s45 offen lds
  s_add_u32 m0, s49, 1024
  s_add_u32 s45, s42, 301056
  buffer_load_dwordx4 v58, s[4:7], s45 offen lds
  s_waitcnt lgkmcnt(0)
  s_barrier
  v_mfma_f32_16x16x32_bf16 v[0:3], v[64:67], v[24:27], 0
  v_mfma_f32_16x16x32_bf16 v[4:7], v[76:79], v[28:31], 0
  v_mfma_f32_16x16x32_bf16 v[8:11], v[88:91], v[32:35], 0
  ds_read_b64 v[24:25], v60 offset:12288
  ds_read_b64 v[26:27], v60 offset:12544
  ds_read_b64 v[28:29], v60 offset:12800
  ds_read_b64 v[30:31], v60 offset:13056
  ds_read_b64 v[32:33], v60 offset:13312
  ds_read_b64 v[34:35], v60 offset:13568
  ds_read_b64 v[48:49], v60 offset:13824
  ds_read_b64 v[50:51], v60 offset:14080
  s_waitcnt lgkmcnt(0)
  v_pk_add_f32 v[24:25], v[24:25], v[32:33]
  v_pk_add_f32 v[26:27], v[26:27], v[34:35]
  v_pk_add_f32 v[28:29], v[28:29], v[48:49]
  v_pk_add_f32 v[30:31], v[30:31], v[50:51]
  v_pk_add_f32 v[24:25], v[24:25], v[28:29]
  v_pk_add_f32 v[26:27], v[26:27], v[30:31]
  v_pk_add_f32 v[24:25], v[24:25], v[26:27]
  v_pk_mul_f32 v[24:25], v[24:25], s[52:53]
  v_mfma_f32_16x16x32_bf16 v[0:3], v[68:71], v[36:39], v[0:3]
  v_fma_f32 v25, -v24, v24, v25
  v_max_f32 v25, s57, v25
  v_mfma_f32_16x16x32_bf16 v[4:7], v[80:83], v[40:43], v[4:7]
  v_rsq_f32 v25, v25
  v_mfma_f32_16x16x32_bf16 v[8:11], v[92:95], v[44:47], v[8:11]
  v_mul_f32 v52, s56, v25
  v_mul_f32 v53, -v24, v52
  v_pk_fma_f32 v[12:13], v[12:13], v[52:53], v[52:53] op_sel:[0,0,1] op_sel_hi:[1,0,1]
  v_pk_fma_f32 v[14:15], v[14:15], v[52:53], v[52:53] op_sel:[0,0,1] op_sel_hi:[1,0,1]
  v_pk_fma_f32 v[16:17], v[16:17], v[52:53], v[52:53] op_sel:[0,0,1] op_sel_hi:[1,0,1]
  v_pk_fma_f32 v[18:19], v[18:19], v[52:53], v[52:53] op_sel:[0,0,1] op_sel_hi:[1,0,1]
  v_pk_fma_f32 v[20:21], v[20:21], v[52:53], v[52:53] op_sel:[0,0,1] op_sel_hi:[1,0,1]
  v_pk_fma_f32 v[22:23], v[22:23], v[52:53], v[52:53] op_sel:[0,0,1] op_sel_hi:[1,0,1]
  v_mfma_f32_16x16x32_bf16 v[0:3], v[72:75], v[100:103], v[0:3]
  v_cvt_pk_bf16_f32 v12, v12, v13
  v_cvt_pk_bf16_f32 v13, v14, v15
  v_mfma_f32_16x16x32_bf16 v[4:7], v[84:87], v[104:107], v[4:7]
  v_cvt_pk_bf16_f32 v14, v16, v17
  v_cvt_pk_bf16_f32 v15, v18, v19
  v_mfma_f32_16x16x32_bf16 v[8:11], v[96:99], v[108:111], v[8:11]
  v_cvt_pk_bf16_f32 v16, v20, v21
  v_cvt_pk_bf16_f32 v17, v22, v23
  ds_write_b64 v61, v[12:13] offset:6656
  ds_write_b64 v61, v[14:15] offset:6672
  ds_write_b64 v61, v[16:17] offset:6688
  s_waitcnt vmcnt(6)
  ds_read_b128 v[24:27], v54 offset:2048
  ds_read_b128 v[28:31], v54 offset:2064
  ds_read_b128 v[32:35], v54 offset:2080
  ds_read_b128 v[36:39], v54 offset:2096
  ds_read_b128 v[40:43], v54 offset:2112
  ds_read_b128 v[44:47], v54 offset:2128
  ds_read_b128 v[100:103], v54 offset:2144
  ds_read_b128 v[104:107], v54 offset:2160
  ds_read_b128 v[108:111], v54 offset:2176
  v_pk_add_f32 v[48:49], v[0:1], v[2:3]
  v_pk_fma_f32 v[50:51], v[0:1], v[0:1], s[54:55]
  v_pk_fma_f32 v[50:51], v[2:3], v[2:3], v[50:51]
  v_pk_add_f32 v[48:49], v[48:49], v[4:5]
  v_pk_fma_f32 v[50:51], v[4:5], v[4:5], v[50:51]
  v_pk_add_f32 v[48:49], v[48:49], v[6:7]
  v_pk_fma_f32 v[50:51], v[6:7], v[6:7], v[50:51]
  v_pk_add_f32 v[48:49], v[48:49], v[8:9]
  v_pk_fma_f32 v[50:51], v[8:9], v[8:9], v[50:51]
  v_pk_add_f32 v[48:49], v[48:49], v[10:11]
  v_pk_fma_f32 v[50:51], v[10:11], v[10:11], v[50:51]
  v_add_f32 v48, v48, v49
  v_add_f32 v49, v50, v51
  ds_write_b64 v59, v[48:49] offset:0
  s_waitcnt lgkmcnt(1)
  s_add_u32 m0, s49, 2048
  s_add_u32 s45, s42, 374784
  buffer_load_dwordx4 v58, s[4:7], s45 offen lds
  s_add_u32 m0, s49, 3072
  s_add_u32 s45, s42, 448512
  buffer_load_dwordx4 v58, s[4:7], s45 offen lds
  s_add_u32 m0, s49, 4096
  s_add_u32 s45, s42, 522240
  buffer_load_dwordx4 v58, s[4:7], s45 offen lds
  s_add_u32 m0, s49, 5120
  s_add_u32 s45, s42, 595968
  buffer_load_dwordx4 v58, s[4:7], s45 offen lds
  s_waitcnt lgkmcnt(0)
  s_barrier
  v_mfma_f32_16x16x32_bf16 v[12:15], v[64:67], v[24:27], 0
  v_mfma_f32_16x16x32_bf16 v[16:19], v[76:79], v[28:31], 0
  v_mfma_f32_16x16x32_bf16 v[20:23], v[88:91], v[32:35], 0
  ds_read_b64 v[24:25], v60 offset:0
  ds_read_b64 v[26:27], v60 offset:256
  ds_read_b64 v[28:29], v60 offset:512
  ds_read_b64 v[30:31], v60 offset:768
  ds_read_b64 v[32:33], v60 offset:1024
  ds_read_b64 v[34:35], v60 offset:1280
  ds_read_b64 v[48:49], v60 offset:1536
  ds_read_b64 v[50:51], v60 offset:1792
  s_waitcnt lgkmcnt(0)
  v_pk_add_f32 v[24:25], v[24:25], v[32:33]
  v_pk_add_f32 v[26:27], v[26:27], v[34:35]
  v_pk_add_f32 v[28:29], v[28:29], v[48:49]
  v_pk_add_f32 v[30:31], v[30:31], v[50:51]
  v_pk_add_f32 v[24:25], v[24:25], v[28:29]
  v_pk_add_f32 v[26:27], v[26:27], v[30:31]
  v_pk_add_f32 v[24:25], v[24:25], v[26:27]
  v_pk_mul_f32 v[24:25], v[24:25], s[52:53]
  v_mfma_f32_16x16x32_bf16 v[12:15], v[68:71], v[36:39], v[12:15]
  v_fma_f32 v25, -v24, v24, v25
  v_max_f32 v25, s57, v25
  v_mfma_f32_16x16x32_bf16 v[16:19], v[80:83], v[40:43], v[16:19]
  v_rsq_f32 v25, v25
  v_mfma_f32_16x16x32_bf16 v[20:23], v[92:95], v[44:47], v[20:23]
  v_mul_f32 v52, s56, v25
  v_mul_f32 v53, -v24, v52
  v_pk_fma_f32 v[0:1], v[0:1], v[52:53], v[52:53] op_sel:[0,0,1] op_sel_hi:[1,0,1]
  v_pk_fma_f32 v[2:3], v[2:3], v[52:53], v[52:53] op_sel:[0,0,1] op_sel_hi:[1,0,1]
  v_pk_fma_f32 v[4:5], v[4:5], v[52:53], v[52:53] op_sel:[0,0,1] op_sel_hi:[1,0,1]
  v_pk_fma_f32 v[6:7], v[6:7], v[52:53], v[52:53] op_sel:[0,0,1] op_sel_hi:[1,0,1]
  v_pk_fma_f32 v[8:9], v[8:9], v[52:53], v[52:53] op_sel:[0,0,1] op_sel_hi:[1,0,1]
  v_pk_fma_f32 v[10:11], v[10:11], v[52:53], v[52:53] op_sel:[0,0,1] op_sel_hi:[1,0,1]
  v_mfma_f32_16x16x32_bf16 v[12:15], v[72:75], v[100:103], v[12:15]
  v_cvt_pk_bf16_f32 v0, v0, v1
  v_cvt_pk_bf16_f32 v1, v2, v3
  v_mfma_f32_16x16x32_bf16 v[16:19], v[84:87], v[104:107], v[16:19]
  v_cvt_pk_bf16_f32 v2, v4, v5
  v_cvt_pk_bf16_f32 v3, v6, v7
  v_mfma_f32_16x16x32_bf16 v[20:23], v[96:99], v[108:111], v[20:23]
  v_cvt_pk_bf16_f32 v4, v8, v9
  v_cvt_pk_bf16_f32 v5, v10, v11
  ds_write_b64 v61, v[0:1] offset:0
  ds_write_b64 v61, v[2:3] offset:16
  ds_write_b64 v61, v[4:5] offset:32
  s_waitcnt vmcnt(6)
  ds_read_b128 v[24:27], v54 offset:6144
  ds_read_b128 v[28:31], v54 offset:6160
  ds_read_b128 v[32:35], v54 offset:6176
  ds_read_b128 v[36:39], v54 offset:6192
  ds_read_b128 v[40:43], v54 offset:6208
  ds_read_b128 v[44:47], v54 offset:6224
  ds_read_b128 v[100:103], v54 offset:6240
  ds_read_b128 v[104:107], v54 offset:6256
  ds_read_b128 v[108:111], v54 offset:6272
  v_pk_add_f32 v[48:49], v[12:13], v[14:15]
  v_pk_fma_f32 v[50:51], v[12:13], v[12:13], s[54:55]
  v_pk_fma_f32 v[50:51], v[14:15], v[14:15], v[50:51]
  v_pk_add_f32 v[48:49], v[48:49], v[16:17]
  v_pk_fma_f32 v[50:51], v[16:17], v[16:17], v[50:51]
  v_pk_add_f32 v[48:49], v[48:49], v[18:19]
  v_pk_fma_f32 v[50:51], v[18:19], v[18:19], v[50:51]
  v_pk_add_f32 v[48:49], v[48:49], v[20:21]
  v_pk_fma_f32 v[50:51], v[20:21], v[20:21], v[50:51]
  v_pk_add_f32 v[48:49], v[48:49], v[22:23]
  v_pk_fma_f32 v[50:51], v[22:23], v[22:23], v[50:51]
  v_add_f32 v48, v48, v49
  v_add_f32 v49, v50, v51
  ds_write_b64 v59, v[48:49] offset:12288
  s_waitcnt lgkmcnt(1)
  s_add_u32 m0, s49, 6144
  s_add_u32 s45, s42, 669696
  buffer_load_dwordx4 v58, s[4:7], s45 offen lds
  s_add_u32 m0, s49, 7168
  s_add_u32 s45, s42, 743424
  buffer_load_dwordx4 v58, s[4:7], s45 offen lds
  s_waitcnt lgkmcnt(0)
  s_barrier
  v_mfma_f32_16x16x32_bf16 v[0:3], v[64:67], v[24:27], 0
  v_mfma_f32_16x16x32_bf16 v[4:7], v[76:79], v[28:31], 0
  v_mfma_f32_16x16x32_bf16 v[8:11], v[88:91], v[32:35], 0
  ds_read_b64 v[24:25], v60 offset:12288
  ds_read_b64 v[26:27], v60 offset:12544
  ds_read_b64 v[28:29], v60 offset:12800
  ds_read_b64 v[30:31], v60 offset:13056
  ds_read_b64 v[32:33], v60 offset:13312
  ds_read_b64 v[34:35], v60 offset:13568
  ds_read_b64 v[48:49], v60 offset:13824
  ds_read_b64 v[50:51], v60 offset:14080
  s_waitcnt lgkmcnt(0)
  v_pk_add_f32 v[24:25], v[24:25], v[32:33]
  v_pk_add_f32 v[26:27], v[26:27], v[34:35]
  v_pk_add_f32 v[28:29], v[28:29], v[48:49]
  v_pk_add_f32 v[30:31], v[30:31], v[50:51]
  v_pk_add_f32 v[24:25], v[24:25], v[28:29]
  v_pk_add_f32 v[26:27], v[26:27], v[30:31]
  v_pk_add_f32 v[24:25], v[24:25], v[26:27]
  v_pk_mul_f32 v[24:25], v[24:25], s[52:53]
  v_mfma_f32_16x16x32_bf16 v[0:3], v[68:71], v[36:39], v[0:3]
  v_fma_f32 v25, -v24, v24, v25
  v_max_f32 v25, s57, v25
  v_mfma_f32_16x16x32_bf16 v[4:7], v[80:83], v[40:43], v[4:7]
  v_rsq_f32 v25, v25
  v_mfma_f32_16x16x32_bf16 v[8:11], v[92:95], v[44:47], v[8:11]
  v_mul_f32 v52, s56, v25
  v_mul_f32 v53, -v24, v52
  v_pk_fma_f32 v[12:13], v[12:13], v[52:53], v[52:53] op_sel:[0,0,1] op_sel_hi:[1,0,1]
  v_pk_fma_f32 v[14:15], v[14:15], v[52:53], v[52:53] op_sel:[0,0,1] op_sel_hi:[1,0,1]
  v_pk_fma_f32 v[16:17], v[16:17], v[52:53], v[52:53] op_sel:[0,0,1] op_sel_hi:[1,0,1]
  v_pk_fma_f32 v[18:19], v[18:19], v[52:53], v[52:53] op_sel:[0,0,1] op_sel_hi:[1,0,1]
  v_pk_fma_f32 v[20:21], v[20:21], v[52:53], v[52:53] op_sel:[0,0,1] op_sel_hi:[1,0,1]
  v_pk_fma_f32 v[22:23], v[22:23], v[52:53], v[52:53] op_sel:[0,0,1] op_sel_hi:[1,0,1]
  v_mfma_f32_16x16x32_bf16 v[0:3], v[72:75], v[100:103], v[0:3]
  v_cvt_pk_bf16_f32 v12, v12, v13
  v_cvt_pk_bf16_f32 v13, v14, v15
  v_mfma_f32_16x16x32_bf16 v[4:7], v[84:87], v[104:107], v[4:7]
  v_cvt_pk_bf16_f32 v14, v16, v17
  v_cvt_pk_bf16_f32 v15, v18, v19
  v_mfma_f32_16x16x32_bf16 v[8:11], v[96:99], v[108:111], v[8:11]
  v_cvt_pk_bf16_f32 v16, v20, v21
  v_cvt_pk_bf16_f32 v17, v22, v23
  ds_write_b64 v61, v[12:13] offset:6656
  ds_write_b64 v61, v[14:15] offset:6672
  ds_write_b64 v61, v[16:17] offset:6688
  s_waitcnt vmcnt(6)
  ds_read_b128 v[24:27], v55 offset:0
  ds_read_b128 v[28:31], v55 offset:16
  ds_read_b128 v[32:35], v55 offset:32
  ds_read_b128 v[36:39], v55 offset:48
  ds_read_b128 v[40:43], v55 offset:64
  ds_read_b128 v[44:47], v55 offset:80
  ds_read_b128 v[100:103], v55 offset:96
  ds_read_b128 v[104:107], v55 offset:112
  ds_read_b128 v[108:111], v55 offset:128
  v_pk_add_f32 v[48:49], v[0:1], v[2:3]
  v_pk_fma_f32 v[50:51], v[0:1], v[0:1], s[54:55]
  v_pk_fma_f32 v[50:51], v[2:3], v[2:3], v[50:51]
  v_pk_add_f32 v[48:49], v[48:49], v[4:5]
  v_pk_fma_f32 v[50:51], v[4:5], v[4:5], v[50:51]
  v_pk_add_f32 v[48:49], v[48:49], v[6:7]
  v_pk_fma_f32 v[50:51], v[6:7], v[6:7], v[50:51]
  v_pk_add_f32 v[48:49], v[48:49], v[8:9]
  v_pk_fma_f32 v[50:51], v[8:9], v[8:9], v[50:51]
  v_pk_add_f32 v[48:49], v[48:49], v[10:11]
  v_pk_fma_f32 v[50:51], v[10:11], v[10:11], v[50:51]
  v_add_f32 v48, v48, v49
  v_add_f32 v49, v50, v51
  ds_write_b64 v59, v[48:49] offset:0
  s_waitcnt lgkmcnt(1)
  s_add_u32 m0, s49, 8192
  s_add_u32 s45, s42, 817152
  buffer_load_dwordx4 v58, s[4:7], s45 offen lds
  s_add_u32 m0, s49, 9216
  s_add_u32 s45, s44, 6144
  buffer_load_dwordx4 v58, s[4:7], s45 offen lds
  s_waitcnt lgkmcnt(0)
  s_barrier
  v_mfma_f32_16x16x32_bf16 v[12:15], v[64:67], v[24:27], 0
  v_mfma_f32_16x16x32_bf16 v[16:19], v[76:79], v[28:31], 0
  v_mfma_f32_16x16x32_bf16 v[20:23], v[88:91], v[32:35], 0
  ds_read_b64 v[24:25], v60 offset:0
  ds_read_b64 v[26:27], v60 offset:256
  ds_read_b64 v[28:29], v60 offset:512
  ds_read_b64 v[30:31], v60 offset:768
  ds_read_b64 v[32:33], v60 offset:1024
  ds_read_b64 v[34:35], v60 offset:1280
  ds_read_b64 v[48:49], v60 offset:1536
  ds_read_b64 v[50:51], v60 offset:1792
  s_waitcnt lgkmcnt(0)
  v_pk_add_f32 v[24:25], v[24:25], v[32:33]
  v_pk_add_f32 v[26:27], v[26:27], v[34:35]
  v_pk_add_f32 v[28:29], v[28:29], v[48:49]
  v_pk_add_f32 v[30:31], v[30:31], v[50:51]
  v_pk_add_f32 v[24:25], v[24:25], v[28:29]
  v_pk_add_f32 v[26:27], v[26:27], v[30:31]
  v_pk_add_f32 v[24:25], v[24:25], v[26:27]
  v_pk_mul_f32 v[24:25], v[24:25], s[52:53]
  v_mfma_f32_16x16x32_bf16 v[12:15], v[68:71], v[36:39], v[12:15]
  v_fma_f32 v25, -v24, v24, v25
  v_max_f32 v25, s57, v25
  v_mfma_f32_16x16x32_bf16 v[16:19], v[80:83], v[40:43], v[16:19]
  v_rsq_f32 v25, v25
  v_mfma_f32_16x16x32_bf16 v[20:23], v[92:95], v[44:47], v[20:23]
  v_mul_f32 v52, s56, v25
  v_mul_f32 v53, -v24, v52
  v_pk_fma_f32 v[0:1], v[0:1], v[52:53], v[52:53] op_sel:[0,0,1] op_sel_hi:[1,0,1]
  v_pk_fma_f32 v[2:3], v[2:3], v[52:53], v[52:53] op_sel:[0,0,1] op_sel_hi:[1,0,1]
  v_pk_fma_f32 v[4:5], v[4:5], v[52:53], v[52:53] op_sel:[0,0,1] op_sel_hi:[1,0,1]
  v_pk_fma_f32 v[6:7], v[6:7], v[52:53], v[52:53] op_sel:[0,0,1] op_sel_hi:[1,0,1]
  v_pk_fma_f32 v[8:9], v[8:9], v[52:53], v[52:53] op_sel:[0,0,1] op_sel_hi:[1,0,1]
  v_pk_fma_f32 v[10:11], v[10:11], v[52:53], v[52:53] op_sel:[0,0,1] op_sel_hi:[1,0,1]
  v_mfma_f32_16x16x32_bf16 v[12:15], v[72:75], v[100:103], v[12:15]
  v_cvt_pk_bf16_f32 v0, v0, v1
  v_cvt_pk_bf16_f32 v1, v2, v3
  v_mfma_f32_16x16x32_bf16 v[16:19], v[84:87], v[104:107], v[16:19]
  v_cvt_pk_bf16_f32 v2, v4, v5
  v_cvt_pk_bf16_f32 v3, v6, v7
  v_mfma_f32_16x16x32_bf16 v[20:23], v[96:99], v[108:111], v[20:23]
  v_cvt_pk_bf16_f32 v4, v8, v9
  v_cvt_pk_bf16_f32 v5, v10, v11
  ds_write_b64 v61, v[0:1] offset:0
  ds_write_b64 v61, v[2:3] offset:16
  ds_write_b64 v61, v[4:5] offset:32
  s_waitcnt vmcnt(6)
  ds_read_b128 v[24:27], v54 offset:0
  ds_read_b128 v[28:31], v54 offset:16
  ds_read_b128 v[32:35], v54 offset:32
  ds_read_b128 v[36:39], v54 offset:48
  ds_read_b128 v[40:43], v54 offset:64
  ds_read_b128 v[44:47], v54 offset:80
  ds_read_b128 v[100:103], v54 offset:96
  ds_read_b128 v[104:107], v54 offset:112
  ds_read_b128 v[108:111], v54 offset:128
  v_pk_add_f32 v[48:49], v[12:13], v[14:15]
  v_pk_fma_f32 v[50:51], v[12:13], v[12:13], s[54:55]
  v_pk_fma_f32 v[50:51], v[14:15], v[14:15], v[50:51]
  v_pk_add_f32 v[48:49], v[48:49], v[16:17]
  v_pk_fma_f32 v[50:51], v[16:17], v[16:17], v[50:51]
  v_pk_add_f32 v[48:49], v[48:49], v[18:19]
  v_pk_fma_f32 v[50:51], v[18:19], v[18:19], v[50:51]
  v_pk_add_f32 v[48:49], v[48:49], v[20:21]
  v_pk_fma_f32 v[50:51], v[20:21], v[20:21], v[50:51]
  v_pk_add_f32 v[48:49], v[48:49], v[22:23]
  v_pk_fma_f32 v[50:51], v[22:23], v[22:23], v[50:51]
  v_add_f32 v48, v48, v49
  v_add_f32 v49, v50, v51
  ds_write_b64 v59, v[48:49] offset:12288
  s_waitcnt lgkmcnt(1)
  s_waitcnt lgkmcnt(0)
  s_barrier
  v_mfma_f32_16x16x32_bf16 v[0:3], v[64:67], v[24:27], 0
  v_mfma_f32_16x16x32_bf16 v[4:7], v[76:79], v[28:31], 0
  v_mfma_f32_16x16x32_bf16 v[8:11], v[88:91], v[32:35], 0
  ds_read_b64 v[24:25], v60 offset:12288
  ds_read_b64 v[26:27], v60 offset:12544
  ds_read_b64 v[28:29], v60 offset:12800
  ds_read_b64 v[30:31], v60 offset:13056
  ds_read_b64 v[32:33], v60 offset:13312
  ds_read_b64 v[34:35], v60 offset:13568
  ds_read_b64 v[48:49], v60 offset:13824
  ds_read_b64 v[50:51], v60 offset:14080
  s_waitcnt lgkmcnt(0)
  v_pk_add_f32 v[24:25], v[24:25], v[32:33]
  v_pk_add_f32 v[26:27], v[26:27], v[34:35]
  v_pk_add_f32 v[28:29], v[28:29], v[48:49]
  v_pk_add_f32 v[30:31], v[30:31], v[50:51]
  v_pk_add_f32 v[24:25], v[24:25], v[28:29]
  v_pk_add_f32 v[26:27], v[26:27], v[30:31]
  v_pk_add_f32 v[24:25], v[24:25], v[26:27]
  v_pk_mul_f32 v[24:25], v[24:25], s[52:53]
  v_mfma_f32_16x16x32_bf16 v[0:3], v[68:71], v[36:39], v[0:3]
  v_fma_f32 v25, -v24, v24, v25
  v_max_f32 v25, s57, v25
  v_mfma_f32_16x16x32_bf16 v[4:7], v[80:83], v[40:43], v[4:7]
  v_rsq_f32 v25, v25
  v_mfma_f32_16x16x32_bf16 v[8:11], v[92:95], v[44:47], v[8:11]
  v_mul_f32 v52, s56, v25
  v_mul_f32 v53, -v24, v52
  v_pk_fma_f32 v[12:13], v[12:13], v[52:53], v[52:53] op_sel:[0,0,1] op_sel_hi:[1,0,1]
  v_pk_fma_f32 v[14:15], v[14:15], v[52:53], v[52:53] op_sel:[0,0,1] op_sel_hi:[1,0,1]
  v_pk_fma_f32 v[16:17], v[16:17], v[52:53], v[52:53] op_sel:[0,0,1] op_sel_hi:[1,0,1]
  v_pk_fma_f32 v[18:19], v[18:19], v[52:53], v[52:53] op_sel:[0,0,1] op_sel_hi:[1,0,1]
  v_pk_fma_f32 v[20:21], v[20:21], v[52:53], v[52:53] op_sel:[0,0,1] op_sel_hi:[1,0,1]
  v_pk_fma_f32 v[22:23], v[22:23], v[52:53], v[52:53] op_sel:[0,0,1] op_sel_hi:[1,0,1]
  v_mfma_f32_16x16x32_bf16 v[0:3], v[72:75], v[100:103], v[0:3]
  v_cvt_pk_bf16_f32 v12, v12, v13
  v_cvt_pk_bf16_f32 v13, v14, v15
  v_mfma_f32_16x16x32_bf16 v[4:7], v[84:87], v[104:107], v[4:7]
  v_cvt_pk_bf16_f32 v14, v16, v17
  v_cvt_pk_bf16_f32 v15, v18, v19
  v_mfma_f32_16x16x32_bf16 v[8:11], v[96:99], v[108:111], v[8:11]
  v_cvt_pk_bf16_f32 v16, v20, v21
  v_cvt_pk_bf16_f32 v17, v22, v23
  ds_write_b64 v61, v[12:13] offset:6656
  ds_write_b64 v61, v[14:15] offset:6672
  ds_write_b64 v61, v[16:17] offset:6688
  s_waitcnt vmcnt(4)
  ds_read_b128 v[24:27], v54 offset:2048
  ds_read_b128 v[28:31], v54 offset:2064
  ds_read_b128 v[32:35], v54 offset:2080
  ds_read_b128 v[36:39], v54 offset:2096
  ds_read_b128 v[40:43], v54 offset:2112
  ds_read_b128 v[44:47], v54 offset:2128
  ds_read_b128 v[100:103], v54 offset:2144
  ds_read_b128 v[104:107], v54 offset:2160
  ds_read_b128 v[108:111], v54 offset:2176
  v_pk_add_f32 v[48:49], v[0:1], v[2:3]
  v_pk_fma_f32 v[50:51], v[0:1], v[0:1], s[54:55]
  v_pk_fma_f32 v[50:51], v[2:3], v[2:3], v[50:51]
  v_pk_add_f32 v[48:49], v[48:49], v[4:5]
  v_pk_fma_f32 v[50:51], v[4:5], v[4:5], v[50:51]
  v_pk_add_f32 v[48:49], v[48:49], v[6:7]
  v_pk_fma_f32 v[50:51], v[6:7], v[6:7], v[50:51]
  v_pk_add_f32 v[48:49], v[48:49], v[8:9]
  v_pk_fma_f32 v[50:51], v[8:9], v[8:9], v[50:51]
  v_pk_add_f32 v[48:49], v[48:49], v[10:11]
  v_pk_fma_f32 v[50:51], v[10:11], v[10:11], v[50:51]
  v_add_f32 v48, v48, v49
  v_add_f32 v49, v50, v51
  ds_write_b64 v59, v[48:49] offset:0
  s_waitcnt lgkmcnt(1)
  s_waitcnt lgkmcnt(0)
  s_barrier
  v_mfma_f32_16x16x32_bf16 v[12:15], v[64:67], v[24:27], 0
  v_mfma_f32_16x16x32_bf16 v[16:19], v[76:79], v[28:31], 0
  v_mfma_f32_16x16x32_bf16 v[20:23], v[88:91], v[32:35], 0
  ds_read_b64 v[24:25], v60 offset:0
  ds_read_b64 v[26:27], v60 offset:256
  ds_read_b64 v[28:29], v60 offset:512
  ds_read_b64 v[30:31], v60 offset:768
  ds_read_b64 v[32:33], v60 offset:1024
  ds_read_b64 v[34:35], v60 offset:1280
  ds_read_b64 v[48:49], v60 offset:1536
  ds_read_b64 v[50:51], v60 offset:1792
  s_waitcnt lgkmcnt(0)
  v_pk_add_f32 v[24:25], v[24:25], v[32:33]
  v_pk_add_f32 v[26:27], v[26:27], v[34:35]
  v_pk_add_f32 v[28:29], v[28:29], v[48:49]
  v_pk_add_f32 v[30:31], v[30:31], v[50:51]
  v_pk_add_f32 v[24:25], v[24:25], v[28:29]
  v_pk_add_f32 v[26:27], v[26:27], v[30:31]
  v_pk_add_f32 v[24:25], v[24:25], v[26:27]
  v_pk_mul_f32 v[24:25], v[24:25], s[52:53]
  v_mfma_f32_16x16x32_bf16 v[12:15], v[68:71], v[36:39], v[12:15]
  v_fma_f32 v25, -v24, v24, v25
  v_max_f32 v25, s57, v25
  v_mfma_f32_16x16x32_bf16 v[16:19], v[80:83], v[40:43], v[16:19]
  v_rsq_f32 v25, v25
  v_mfma_f32_16x16x32_bf16 v[20:23], v[92:95], v[44:47], v[20:23]
  v_mul_f32 v52, s56, v25
  v_mul_f32 v53, -v24, v52
  v_pk_fma_f32 v[0:1], v[0:1], v[52:53], v[52:53] op_sel:[0,0,1] op_sel_hi:[1,0,1]
  v_pk_fma_f32 v[2:3], v[2:3], v[52:53], v[52:53] op_sel:[0,0,1] op_sel_hi:[1,0,1]
  v_pk_fma_f32 v[4:5], v[4:5], v[52:53], v[52:53] op_sel:[0,0,1] op_sel_hi:[1,0,1]
  v_pk_fma_f32 v[6:7], v[6:7], v[52:53], v[52:53] op_sel:[0,0,1] op_sel_hi:[1,0,1]
  v_pk_fma_f32 v[8:9], v[8:9], v[52:53], v[52:53] op_sel:[0,0,1] op_sel_hi:[1,0,1]
  v_pk_fma_f32 v[10:11], v[10:11], v[52:53], v[52:53] op_sel:[0,0,1] op_sel_hi:[1,0,1]
  v_mfma_f32_16x16x32_bf16 v[12:15], v[72:75], v[100:103], v[12:15]
  v_cvt_pk_bf16_f32 v0, v0, v1
  v_cvt_pk_bf16_f32 v1, v2, v3
  v_mfma_f32_16x16x32_bf16 v[16:19], v[84:87], v[104:107], v[16:19]
  v_cvt_pk_bf16_f32 v2, v4, v5
  v_cvt_pk_bf16_f32 v3, v6, v7
  v_mfma_f32_16x16x32_bf16 v[20:23], v[96:99], v[108:111], v[20:23]
  v_cvt_pk_bf16_f32 v4, v8, v9
  v_cvt_pk_bf16_f32 v5, v10, v11
  ds_write_b64 v61, v[0:1] offset:0
  ds_write_b64 v61, v[2:3] offset:16
  ds_write_b64 v61, v[4:5] offset:32
  s_waitcnt vmcnt(2)
  ds_read_b128 v[24:27], v54 offset:4096
  ds_read_b128 v[28:31], v54 offset:4112
  ds_read_b128 v[32:35], v54 offset:4128
  ds_read_b128 v[36:39], v54 offset:4144
  ds_read_b128 v[40:43], v54 offset:4160
  ds_read_b128 v[44:47], v54 offset:4176
  ds_read_b128 v[100:103], v54 offset:4192
  ds_read_b128 v[104:107], v54 offset:4208
  ds_read_b128 v[108:111], v54 offset:4224
  v_pk_add_f32 v[48:49], v[12:13], v[14:15]
  v_pk_fma_f32 v[50:51], v[12:13], v[12:13], s[54:55]
  v_pk_fma_f32 v[50:51], v[14:15], v[14:15], v[50:51]
  v_pk_add_f32 v[48:49], v[48:49], v[16:17]
  v_pk_fma_f32 v[50:51], v[16:17], v[16:17], v[50:51]
  v_pk_add_f32 v[48:49], v[48:49], v[18:19]
  v_pk_fma_f32 v[50:51], v[18:19], v[18:19], v[50:51]
  v_pk_add_f32 v[48:49], v[48:49], v[20:21]
  v_pk_fma_f32 v[50:51], v[20:21], v[20:21], v[50:51]
  v_pk_add_f32 v[48:49], v[48:49], v[22:23]
  v_pk_fma_f32 v[50:51], v[22:23], v[22:23], v[50:51]
  v_add_f32 v48, v48, v49
  v_add_f32 v49, v50, v51
  ds_write_b64 v59, v[48:49] offset:12288
  s_waitcnt lgkmcnt(1)
  s_waitcnt lgkmcnt(0)
  s_barrier
  v_mfma_f32_16x16x32_bf16 v[0:3], v[64:67], v[24:27], 0
  v_mfma_f32_16x16x32_bf16 v[4:7], v[76:79], v[28:31], 0
  v_mfma_f32_16x16x32_bf16 v[8:11], v[88:91], v[32:35], 0
  ds_read_b64 v[24:25], v60 offset:12288
  ds_read_b64 v[26:27], v60 offset:12544
  ds_read_b64 v[28:29], v60 offset:12800
  ds_read_b64 v[30:31], v60 offset:13056
  ds_read_b64 v[32:33], v60 offset:13312
  ds_read_b64 v[34:35], v60 offset:13568
  ds_read_b64 v[48:49], v60 offset:13824
  ds_read_b64 v[50:51], v60 offset:14080
  s_waitcnt lgkmcnt(0)
  v_pk_add_f32 v[24:25], v[24:25], v[32:33]
  v_pk_add_f32 v[26:27], v[26:27], v[34:35]
  v_pk_add_f32 v[28:29], v[28:29], v[48:49]
  v_pk_add_f32 v[30:31], v[30:31], v[50:51]
  v_pk_add_f32 v[24:25], v[24:25], v[28:29]
  v_pk_add_f32 v[26:27], v[26:27], v[30:31]
  v_pk_add_f32 v[24:25], v[24:25], v[26:27]
  v_pk_mul_f32 v[24:25], v[24:25], s[52:53]
  v_mfma_f32_16x16x32_bf16 v[0:3], v[68:71], v[36:39], v[0:3]
  v_fma_f32 v25, -v24, v24, v25
  v_max_f32 v25, s57, v25
  v_mfma_f32_16x16x32_bf16 v[4:7], v[80:83], v[40:43], v[4:7]
  v_rsq_f32 v25, v25
  v_mfma_f32_16x16x32_bf16 v[8:11], v[92:95], v[44:47], v[8:11]
  v_mul_f32 v52, s56, v25
  v_mul_f32 v53, -v24, v52
  v_pk_fma_f32 v[12:13], v[12:13], v[52:53], v[52:53] op_sel:[0,0,1] op_sel_hi:[1,0,1]
  v_pk_fma_f32 v[14:15], v[14:15], v[52:53], v[52:53] op_sel:[0,0,1] op_sel_hi:[1,0,1]
  v_pk_fma_f32 v[16:17], v[16:17], v[52:53], v[52:53] op_sel:[0,0,1] op_sel_hi:[1,0,1]
  v_pk_fma_f32 v[18:19], v[18:19], v[52:53], v[52:53] op_sel:[0,0,1] op_sel_hi:[1,0,1]
  v_pk_fma_f32 v[20:21], v[20:21], v[52:53], v[52:53] op_sel:[0,0,1] op_sel_hi:[1,0,1]
  v_pk_fma_f32 v[22:23], v[22:23], v[52:53], v[52:53] op_sel:[0,0,1] op_sel_hi:[1,0,1]
  v_mfma_f32_16x16x32_bf16 v[0:3], v[72:75], v[100:103], v[0:3]
  v_cvt_pk_bf16_f32 v12, v12, v13
  v_cvt_pk_bf16_f32 v13, v14, v15
  v_mfma_f32_16x16x32_bf16 v[4:7], v[84:87], v[104:107], v[4:7]
  v_cvt_pk_bf16_f32 v14, v16, v17
  v_cvt_pk_bf16_f32 v15, v18, v19
  v_mfma_f32_16x16x32_bf16 v[8:11], v[96:99], v[108:111], v[8:11]
  v_cvt_pk_bf16_f32 v16, v20, v21
  v_cvt_pk_bf16_f32 v17, v22, v23
  ds_write_b64 v61, v[12:13] offset:6656
  ds_write_b64 v61, v[14:15] offset:6672
  ds_write_b64 v61, v[16:17] offset:6688
  s_waitcnt vmcnt(0)
  ds_read_b128 v[24:27], v54 offset:6144
  ds_read_b128 v[28:31], v54 offset:6160
  ds_read_b128 v[32:35], v54 offset:6176
  ds_read_b128 v[36:39], v54 offset:6192
  ds_read_b128 v[40:43], v54 offset:6208
  ds_read_b128 v[44:47], v54 offset:6224
  ds_read_b128 v[100:103], v54 offset:6240
  ds_read_b128 v[104:107], v54 offset:6256
  ds_read_b128 v[108:111], v54 offset:6272
  v_pk_add_f32 v[48:49], v[0:1], v[2:3]
  v_pk_fma_f32 v[50:51], v[0:1], v[0:1], s[54:55]
  v_pk_fma_f32 v[50:51], v[2:3], v[2:3], v[50:51]
  v_pk_add_f32 v[48:49], v[48:49], v[4:5]
  v_pk_fma_f32 v[50:51], v[4:5], v[4:5], v[50:51]
  v_pk_add_f32 v[48:49], v[48:49], v[6:7]
  v_pk_fma_f32 v[50:51], v[6:7], v[6:7], v[50:51]
  v_pk_add_f32 v[48:49], v[48:49], v[8:9]
  v_pk_fma_f32 v[50:51], v[8:9], v[8:9], v[50:51]
  v_pk_add_f32 v[48:49], v[48:49], v[10:11]
  v_pk_fma_f32 v[50:51], v[10:11], v[10:11], v[50:51]
  v_add_f32 v48, v48, v49
  v_add_f32 v49, v50, v51
  ds_write_b64 v59, v[48:49] offset:0
  s_waitcnt lgkmcnt(1)
  s_waitcnt lgkmcnt(0)
  s_barrier
  v_mfma_f32_16x16x32_bf16 v[12:15], v[64:67], v[24:27], 0
  v_mfma_f32_16x16x32_bf16 v[16:19], v[76:79], v[28:31], 0
  v_mfma_f32_16x16x32_bf16 v[20:23], v[88:91], v[32:35], 0
  ds_read_b64 v[24:25], v60 offset:0
  ds_read_b64 v[26:27], v60 offset:256
  ds_read_b64 v[28:29], v60 offset:512
  ds_read_b64 v[30:31], v60 offset:768
  ds_read_b64 v[32:33], v60 offset:1024
  ds_read_b64 v[34:35], v60 offset:1280
  ds_read_b64 v[48:49], v60 offset:1536
  ds_read_b64 v[50:51], v60 offset:1792
  s_waitcnt lgkmcnt(0)
  v_pk_add_f32 v[24:25], v[24:25], v[32:33]
  v_pk_add_f32 v[26:27], v[26:27], v[34:35]
  v_pk_add_f32 v[28:29], v[28:29], v[48:49]
  v_pk_add_f32 v[30:31], v[30:31], v[50:51]
  v_pk_add_f32 v[24:25], v[24:25], v[28:29]
  v_pk_add_f32 v[26:27], v[26:27], v[30:31]
  v_pk_add_f32 v[24:25], v[24:25], v[26:27]
  v_pk_mul_f32 v[24:25], v[24:25], s[52:53]
  v_mfma_f32_16x16x32_bf16 v[12:15], v[68:71], v[36:39], v[12:15]
  v_fma_f32 v25, -v24, v24, v25
  v_max_f32 v25, s57, v25
  v_mfma_f32_16x16x32_bf16 v[16:19], v[80:83], v[40:43], v[16:19]
  v_rsq_f32 v25, v25
  v_mfma_f32_16x16x32_bf16 v[20:23], v[92:95], v[44:47], v[20:23]
  v_mul_f32 v52, s56, v25
  v_mul_f32 v53, -v24, v52
  v_pk_fma_f32 v[0:1], v[0:1], v[52:53], v[52:53] op_sel:[0,0,1] op_sel_hi:[1,0,1]
  v_pk_fma_f32 v[2:3], v[2:3], v[52:53], v[52:53] op_sel:[0,0,1] op_sel_hi:[1,0,1]
  v_pk_fma_f32 v[4:5], v[4:5], v[52:53], v[52:53] op_sel:[0,0,1] op_sel_hi:[1,0,1]
  v_pk_fma_f32 v[6:7], v[6:7], v[52:53], v[52:53] op_sel:[0,0,1] op_sel_hi:[1,0,1]
  v_pk_fma_f32 v[8:9], v[8:9], v[52:53], v[52:53] op_sel:[0,0,1] op_sel_hi:[1,0,1]
  v_pk_fma_f32 v[10:11], v[10:11], v[52:53], v[52:53] op_sel:[0,0,1] op_sel_hi:[1,0,1]
  v_mfma_f32_16x16x32_bf16 v[12:15], v[72:75], v[100:103], v[12:15]
  v_cvt_pk_bf16_f32 v0, v0, v1
  v_cvt_pk_bf16_f32 v1, v2, v3
  v_mfma_f32_16x16x32_bf16 v[16:19], v[84:87], v[104:107], v[16:19]
  v_cvt_pk_bf16_f32 v2, v4, v5
  v_cvt_pk_bf16_f32 v3, v6, v7
  v_mfma_f32_16x16x32_bf16 v[20:23], v[96:99], v[108:111], v[20:23]
  v_cvt_pk_bf16_f32 v4, v8, v9
  v_cvt_pk_bf16_f32 v5, v10, v11
  ds_write_b64 v61, v[0:1] offset:0
  ds_write_b64 v61, v[2:3] offset:16
  ds_write_b64 v61, v[4:5] offset:32
  ds_read_b64_tr_b16 v[64:65], v62 offset:0
  ds_read_b64_tr_b16 v[66:67], v63 offset:0
  ds_read_b64_tr_b16 v[68:69], v62 offset:2048
  ds_read_b64_tr_b16 v[70:71], v63 offset:2048
  ds_read_b64_tr_b16 v[72:73], v62 offset:4096
  ds_read_b64_tr_b16 v[74:75], v63 offset:4096
  ds_read_b64_tr_b16 v[76:77], v62 offset:6144
  ds_read_b64_tr_b16 v[78:79], v63 offset:6144
  ds_read_b64_tr_b16 v[80:81], v62 offset:8192
  ds_read_b64_tr_b16 v[82:83], v63 offset:8192
  ds_read_b64_tr_b16 v[84:85], v62 offset:10240
  ds_read_b64_tr_b16 v[86:87], v63 offset:10240
  ds_read_b64_tr_b16 v[88:89], v62 offset:12288
  ds_read_b64_tr_b16 v[90:91], v63 offset:12288
  ds_read_b64_tr_b16 v[92:93], v62 offset:14336
  ds_read_b64_tr_b16 v[94:95], v63 offset:14336
  ds_read_b64_tr_b16 v[96:97], v62 offset:16384
  ds_read_b64_tr_b16 v[98:99], v63 offset:16384
  ds_read_b64_tr_b16 v[100:101], v62 offset:18432
  ds_read_b64_tr_b16 v[102:103], v63 offset:18432
  ds_read_b64_tr_b16 v[104:105], v62 offset:20480
  ds_read_b64_tr_b16 v[106:107], v63 offset:20480
  ds_read_b64_tr_b16 v[108:109], v62 offset:22528
  ds_read_b64_tr_b16 v[110:111], v63 offset:22528
  s_nop 7
  v_pk_add_f32 v[48:49], v[12:13], v[14:15]
  v_pk_fma_f32 v[50:51], v[12:13], v[12:13], s[54:55]
  v_pk_fma_f32 v[50:51], v[14:15], v[14:15], v[50:51]
  v_pk_add_f32 v[48:49], v[48:49], v[16:17]
  v_pk_fma_f32 v[50:51], v[16:17], v[16:17], v[50:51]
  v_pk_add_f32 v[48:49], v[48:49], v[18:19]
  v_pk_fma_f32 v[50:51], v[18:19], v[18:19], v[50:51]
  v_pk_add_f32 v[48:49], v[48:49], v[20:21]
  v_pk_fma_f32 v[50:51], v[20:21], v[20:21], v[50:51]
  v_pk_add_f32 v[48:49], v[48:49], v[22:23]
  v_pk_fma_f32 v[50:51], v[22:23], v[22:23], v[50:51]
  v_add_f32 v48, v48, v49
  v_add_f32 v49, v50, v51
  v_add_u32 v59, 52224, v59
  v_add_u32 v60, 52224, v60
  ds_write_b64 v59, v[48:49] offset:0
  s_cmp_lg_u32 s41, 0
  s_cbranch_scc1 L_H0
  v_mov_b32 v44, 0
  buffer_load_dword v45, v44, s[36:39], 0 offen sc1
L_H0:
  s_waitcnt lgkmcnt(0)
  s_barrier
  ds_read_b64 v[24:25], v60 offset:0
  ds_read_b64 v[26:27], v60 offset:256
  ds_read_b64 v[28:29], v60 offset:512
  ds_read_b64 v[30:31], v60 offset:768
  ds_read_b64 v[32:33], v60 offset:1024
  ds_read_b64 v[34:35], v60 offset:1280
  ds_read_b64 v[48:49], v60 offset:1536
  ds_read_b64 v[50:51], v60 offset:1792
  s_waitcnt lgkmcnt(0)
  v_pk_add_f32 v[24:25], v[24:25], v[32:33]
  v_pk_add_f32 v[26:27], v[26:27], v[34:35]
  v_pk_add_f32 v[28:29], v[28:29], v[48:49]
  v_pk_add_f32 v[30:31], v[30:31], v[50:51]
  v_pk_add_f32 v[24:25], v[24:25], v[28:29]
  v_pk_add_f32 v[26:27], v[26:27], v[30:31]
  v_pk_add_f32 v[24:25], v[24:25], v[26:27]
  v_pk_mul_f32 v[24:25], v[24:25], s[52:53]
  v_fma_f32 v25, -v24, v24, v25
  v_max_f32 v25, s57, v25
  v_rsq_f32 v25, v25
  s_nop 0
  v_mul_f32 v52, s56, v25
  v_mul_f32 v53, -v24, v52
  v_pk_fma_f32 v[12:13], v[12:13], v[52:53], v[52:53] op_sel:[0,0,1] op_sel_hi:[1,0,1]
  v_pk_fma_f32 v[14:15], v[14:15], v[52:53], v[52:53] op_sel:[0,0,1] op_sel_hi:[1,0,1]
  v_pk_fma_f32 v[16:17], v[16:17], v[52:53], v[52:53] op_sel:[0,0,1] op_sel_hi:[1,0,1]
  v_pk_fma_f32 v[18:19], v[18:19], v[52:53], v[52:53] op_sel:[0,0,1] op_sel_hi:[1,0,1]
  v_pk_fma_f32 v[20:21], v[20:21], v[52:53], v[52:53] op_sel:[0,0,1] op_sel_hi:[1,0,1]
  v_pk_fma_f32 v[22:23], v[22:23], v[52:53], v[52:53] op_sel:[0,0,1] op_sel_hi:[1,0,1]
  v_cvt_pk_bf16_f32 v12, v12, v13
  v_cvt_pk_bf16_f32 v13, v14, v15
  v_cvt_pk_bf16_f32 v14, v16, v17
  v_cvt_pk_bf16_f32 v15, v18, v19
  v_cvt_pk_bf16_f32 v16, v20, v21
  v_cvt_pk_bf16_f32 v17, v22, v23
  ds_write_b64 v61, v[12:13] offset:6656
  ds_write_b64 v61, v[14:15] offset:6672
  ds_write_b64 v61, v[16:17] offset:6688
  s_cmp_lg_u32 s41, 0
  s_cbranch_scc1 L_H5
  s_mov_b32 s46, 200000
L_H4:
  s_waitcnt vmcnt(0)
  v_readfirstlane_b32 s48, v45
  s_cmp_ge_u32 s48, 328
  s_cbranch_scc1 L_H5
  buffer_load_dword v45, v44, s[36:39], 0 offen sc1
  s_sub_u32 s46, s46, 1
  s_cmp_lg_u32 s46, 0
  s_cbranch_scc1 L_H4
L_H5:
  s_waitcnt lgkmcnt(0)
  s_barrier
  s_setprio 0
  s_waitcnt vmcnt(0)
  v_mbcnt_lo_u32_b32 v2, -1, 0
  v_mbcnt_hi_u32_b32 v2, -1, v2
  v_min_u32 v5, 23, v2
  s_mul_i32 s45, s41, 96
  v_lshl_add_u32 v5, v5, 2, s45
  s_mov_b32 s45, 622592
  s_mov_b32 s46, 624896
  buffer_load_dword v16, v5, s[12:15], s45 offen offset:0 sc1
  buffer_load_dword v17, v5, s[12:15], s45 offen offset:384 sc1
  buffer_load_dword v18, v5, s[12:15], s45 offen offset:768 sc1
  buffer_load_dword v19, v5, s[12:15], s45 offen offset:1152 sc1
  buffer_load_dword v20, v5, s[12:15], s45 offen offset:1536 sc1
  buffer_load_dword v21, v5, s[12:15], s45 offen offset:1920 sc1
  buffer_load_dword v22, v5, s[12:15], s46 offen offset:0 sc1
  buffer_load_dword v23, v5, s[12:15], s46 offen offset:384 sc1
  buffer_load_dword v24, v5, s[12:15], s46 offen offset:768 sc1
  buffer_load_dword v25, v5, s[12:15], s46 offen offset:1152 sc1
  buffer_load_dword v26, v5, s[12:15], s46 offen offset:1536 sc1
  buffer_load_dword v27, v5, s[12:15], s46 offen offset:1920 sc1
  v_mbcnt_lo_u32_b32 v2, -1, 0
  v_mbcnt_hi_u32_b32 v2, -1, v2
  v_lshlrev_b32 v0, 4, v2
  v_lshrrev_b32 v3, 4, v2
  s_mul_i32 s45, s41, 6144
  s_add_u32 s46, s45, 548864
  buffer_load_dwordx4 v[32:35], v0, s[12:15], s46 offen sc1
  s_add_u32 s46, s45, 549888
  buffer_load_dwordx4 v[36:39], v0, s[12:15], s46 offen sc1
  s_add_u32 s46, s45, 550912
  buffer_load_dwordx4 v[40:43], v0, s[12:15], s46 offen sc1
  s_add_u32 s46, s45, 551936
  buffer_load_dwordx4 v[44:47], v0, s[12:15], s46 offen sc1
  s_add_u32 s46, s45, 552960
  buffer_load_dwordx4 v[48:51], v0, s[12:15], s46 offen sc1
  s_add_u32 s46, s45, 553984
  buffer_load_dwordx4 v[52:55], v0, s[12:15], s46 offen sc1
  s_add_u32 s45, s45, 24576
  v_add_u32 v62, 49152, v0
  v_add_u32 v61, s45, v62
  v_and_b32 v1, 15, v2
  v_mul_u32_u24 v60, 192, v1
  v_lshl_add_u32 v60, v3, 4, v60
  s_mul_i32 s45, s41, 384
  s_add_u32 s45, s45, 147456
  v_lshl_add_u32 v59, v3, 5, s45
  s_lshl_b32 s45, s41, 13
  s_add_u32 s45, s45, L_GWIN - L_PC
  v_lshlrev_b32 v1, 7, v2
  buffer_load_dword v3, v1, s[84:87], s45 offen
  s_mul_i32 s60, s41, 73728
  s_add_u32 s60, s60, s42
  s_add_u32 s60, s60, 6144
  s_mul_i32 s61, s41, 73728
  s_add_u32 s61, s61, s42
  s_add_u32 s61, s61, 0
  s_mul_i32 s62, s41, 73728
  s_add_u32 s62, s62, s42
  s_add_u32 s62, s62, 294912
  s_mul_i32 s63, s41, 73728
  s_add_u32 s63, s63, s42
  s_add_u32 s63, s63, 589824
  s_waitcnt lgkmcnt(0)
  s_barrier
  s_waitcnt vmcnt(0)
  v_add_f32 v16, v16, v22
  v_add_f32 v17, v17, v23
  v_add_f32 v18, v18, v24
  v_add_f32 v19, v19, v25
  v_add_f32 v20, v20, v26
  v_add_f32 v21, v21, v27
  v_add_f32 v16, v16, v19
  v_add_f32 v17, v17, v20
  v_add_f32 v18, v18, v21
  v_add_f32 v4, v16, v17
  v_add_f32 v4, v4, v18
  v_add_u32 v5, 147456, v5
  ds_write_b32 v5, v4 offset:2048
  v_lshlrev_b32 v16, 16, v32
  v_and_b32 v17, 0xffff0000, v32
  v_lshlrev_b32 v18, 16, v33
  v_and_b32 v19, 0xffff0000, v33
  v_lshlrev_b32 v20, 16, v34
  v_and_b32 v21, 0xffff0000, v34
  v_lshlrev_b32 v22, 16, v35
  v_and_b32 v23, 0xffff0000, v35
  v_lshlrev_b32 v24, 16, v36
  v_and_b32 v25, 0xffff0000, v36
  v_lshlrev_b32 v26, 16, v37
  v_and_b32 v27, 0xffff0000, v37
  v_lshlrev_b32 v28, 16, v38
  v_and_b32 v29, 0xffff0000, v38
  v_lshlrev_b32 v30, 16, v39
  v_and_b32 v31, 0xffff0000, v39
  v_lshlrev_b32 v32, 16, v40
  v_and_b32 v33, 0xffff0000, v40
  v_lshlrev_b32 v34, 16, v41
  v_and_b32 v35, 0xffff0000, v41
  v_lshlrev_b32 v36, 16, v42
  v_and_b32 v37, 0xffff0000, v42
  v_lshlrev_b32 v38, 16, v43
  v_and_b32 v39, 0xffff0000, v43
  v_lshlrev_b32 v40, 16, v44
  v_and_b32 v41, 0xffff0000, v44
  v_lshlrev_b32 v42, 16, v45
  v_and_b32 v43, 0xffff0000, v45
  v_lshlrev_b32 v44, 16, v46
  v_and_b32 v45, 0xffff0000, v46
  v_lshlrev_b32 v46, 16, v47
  v_and_b32 v47, 0xffff0000, v47
  s_barrier
  s_mul_i32 s45, s41, 6144
  s_add_u32 m0, s45, 98304
  s_add_u32 s46, s45, 573440
  buffer_load_dwordx4 v0, s[12:15], s46 offen sc1 lds
  s_add_u32 m0, s45, 99328
  s_add_u32 s46, s45, 574464
  buffer_load_dwordx4 v0, s[12:15], s46 offen sc1 lds
  s_add_u32 m0, s45, 100352
  s_add_u32 s46, s45, 575488
  buffer_load_dwordx4 v0, s[12:15], s46 offen sc1 lds
  s_add_u32 m0, s45, 101376
  s_add_u32 s46, s45, 576512
  buffer_load_dwordx4 v0, s[12:15], s46 offen sc1 lds
  s_add_u32 m0, s45, 102400
  s_add_u32 s46, s45, 577536
  buffer_load_dwordx4 v0, s[12:15], s46 offen sc1 lds
  s_add_u32 m0, s45, 103424
  s_add_u32 s46, s45, 578560
  buffer_load_dwordx4 v0, s[12:15], s46 offen sc1 lds
L_PREPG:
  s_mov_b32 s57, 147456
  s_waitcnt vmcnt(0) lgkmcnt(0)
  s_barrier
  ds_read_b128 v[0:3], v59 offset:0
  ds_read_b128 v[4:7], v59 offset:16
  ds_read_b128 v[8:11], v59 offset:128
  ds_read_b128 v[12:15], v59 offset:144
  s_waitcnt lgkmcnt(2)
  v_pk_mul_f32 v[16:17], v[16:17], v[0:1]
  v_pk_mul_f32 v[18:19], v[18:19], v[2:3]
  v_pk_mul_f32 v[20:21], v[20:21], v[4:5]
  v_pk_mul_f32 v[22:23], v[22:23], v[6:7]
  v_cvt_pk_bf16_f32 v16, v16, v17
  v_cvt_pk_bf16_f32 v17, v18, v19
  v_cvt_pk_bf16_f32 v18, v20, v21
  v_cvt_pk_bf16_f32 v19, v22, v23
  ds_write_b128 v61, v[16:19] offset:0
  v_pk_mul_f32 v[24:25], v[24:25], v[0:1]
  v_pk_mul_f32 v[26:27], v[26:27], v[2:3]
  v_pk_mul_f32 v[28:29], v[28:29], v[4:5]
  v_pk_mul_f32 v[30:31], v[30:31], v[6:7]
  v_cvt_pk_bf16_f32 v24, v24, v25
  v_cvt_pk_bf16_f32 v25, v26, v27
  v_cvt_pk_bf16_f32 v26, v28, v29
  v_cvt_pk_bf16_f32 v27, v30, v31
  ds_read_b128 v[0:3], v59 offset:256
  ds_read_b128 v[4:7], v59 offset:272
  ds_write_b128 v61, v[24:27] offset:1024
  s_waitcnt lgkmcnt(4)
  v_pk_mul_f32 v[32:33], v[32:33], v[8:9]
  v_pk_mul_f32 v[34:35], v[34:35], v[10:11]
  v_pk_mul_f32 v[36:37], v[36:37], v[12:13]
  v_pk_mul_f32 v[38:39], v[38:39], v[14:15]
  v_cvt_pk_bf16_f32 v32, v32, v33
  v_cvt_pk_bf16_f32 v33, v34, v35
  v_cvt_pk_bf16_f32 v34, v36, v37
  v_cvt_pk_bf16_f32 v35, v38, v39
  ds_write_b128 v61, v[32:35] offset:2048
  v_pk_mul_f32 v[40:41], v[40:41], v[8:9]
  v_pk_mul_f32 v[42:43], v[42:43], v[10:11]
  v_pk_mul_f32 v[44:45], v[44:45], v[12:13]
  v_pk_mul_f32 v[46:47], v[46:47], v[14:15]
  v_cvt_pk_bf16_f32 v40, v40, v41
  v_cvt_pk_bf16_f32 v41, v42, v43
  v_cvt_pk_bf16_f32 v42, v44, v45
  v_cvt_pk_bf16_f32 v43, v46, v47
  ds_write_b128 v61, v[40:43] offset:3072
  s_waitcnt lgkmcnt(2)
  v_lshlrev_b32 v16, 16, v48
  v_and_b32 v17, 0xffff0000, v48
  v_lshlrev_b32 v18, 16, v49
  v_and_b32 v19, 0xffff0000, v49
  v_lshlrev_b32 v20, 16, v50
  v_and_b32 v21, 0xffff0000, v50
  v_lshlrev_b32 v22, 16, v51
  v_and_b32 v23, 0xffff0000, v51
  v_pk_mul_f32 v[16:17], v[16:17], v[0:1]
  v_pk_mul_f32 v[18:19], v[18:19], v[2:3]
  v_pk_mul_f32 v[20:21], v[20:21], v[4:5]
  v_pk_mul_f32 v[22:23], v[22:23], v[6:7]
  v_cvt_pk_bf16_f32 v16, v16, v17
  v_cvt_pk_bf16_f32 v17, v18, v19
  v_cvt_pk_bf16_f32 v18, v20, v21
  v_cvt_pk_bf16_f32 v19, v22, v23
  ds_write_b128 v61, v[16:19] offset:4096
  v_lshlrev_b32 v24, 16, v52
  v_and_b32 v25, 0xffff0000, v52
  v_lshlrev_b32 v26, 16, v53
  v_and_b32 v27, 0xffff0000, v53
  v_lshlrev_b32 v28, 16, v54
  v_and_b32 v29, 0xffff0000, v54
  v_lshlrev_b32 v30, 16, v55
  v_and_b32 v31, 0xffff0000, v55
  v_pk_mul_f32 v[24:25], v[24:25], v[0:1]
  v_pk_mul_f32 v[26:27], v[26:27], v[2:3]
  v_pk_mul_f32 v[28:29], v[28:29], v[4:5]
  v_pk_mul_f32 v[30:31], v[30:31], v[6:7]
  v_cvt_pk_bf16_f32 v24, v24, v25
  v_cvt_pk_bf16_f32 v25, v26, v27
  v_cvt_pk_bf16_f32 v26, v28, v29
  v_cvt_pk_bf16_f32 v27, v30, v31
  ds_write_b128 v61, v[24:27] offset:5120
  v_and_b32 v61, 0x30, v60
  v_lshl_add_u32 v61, v61, 1, s57
  ds_read_b128 v[24:27], v61 offset:2048
  ds_read_b128 v[28:31], v61 offset:2064
  ds_read_b128 v[32:35], v61 offset:2048
  ds_read_b128 v[36:39], v61 offset:2064
  ds_read_b128 v[40:43], v61 offset:2048
  ds_read_b128 v[44:47], v61 offset:2064
  ds_read_b128 v[48:51], v61 offset:2048
  ds_read_b128 v[52:55], v61 offset:2064
  s_waitcnt lgkmcnt(8)
  s_barrier
  s_cmp_ge_u32 s40, 4
  s_cbranch_scc1 L_HP2
L_RM:
  ds_read_b128 v[16:19], v62 offset:0
  ds_read_b128 v[20:23], v62 offset:1024
  buffer_load_dwordx4 v[0:3], v60, s[4:7], s60 offen offset:192
  buffer_load_dwordx4 v[4:7], v60, s[4:7], s61 offen offset:192
  buffer_load_dwordx4 v[8:11], v60, s[4:7], s62 offen offset:192
  buffer_load_dwordx4 v[12:15], v60, s[4:7], s63 offen offset:192
  s_setprio 3
  s_waitcnt lgkmcnt(1)
  v_mfma_f32_16x16x32_bf16 v[24:27], v[16:19], v[64:67], v[24:27]
  ds_read_b128 v[56:59], v62 offset:2048
  v_mfma_f32_16x16x32_bf16 v[32:35], v[16:19], v[112:115], v[32:35]
  v_mfma_f32_16x16x32_bf16 v[40:43], v[16:19], v[160:163], v[40:43]
  v_mfma_f32_16x16x32_bf16 v[48:51], v[16:19], v[208:211], v[48:51]
  s_waitcnt lgkmcnt(1)
  v_mfma_f32_16x16x32_bf16 v[52:55], v[20:23], v[208:211], v[52:55]
  ds_read_b128 v[16:19], v62 offset:3072
  v_mfma_f32_16x16x32_bf16 v[44:47], v[20:23], v[160:163], v[44:47]
  v_mfma_f32_16x16x32_bf16 v[36:39], v[20:23], v[112:115], v[36:39]
  v_mfma_f32_16x16x32_bf16 v[28:31], v[20:23], v[64:67], v[28:31]
  s_waitcnt lgkmcnt(1)
  v_mfma_f32_16x16x32_bf16 v[24:27], v[56:59], v[68:71], v[24:27]
  ds_read_b128 v[20:23], v62 offset:4096
  v_mfma_f32_16x16x32_bf16 v[32:35], v[56:59], v[116:119], v[32:35]
  v_mfma_f32_16x16x32_bf16 v[40:43], v[56:59], v[164:167], v[40:43]
  v_mfma_f32_16x16x32_bf16 v[48:51], v[56:59], v[212:215], v[48:51]
  s_waitcnt lgkmcnt(1)
  v_mfma_f32_16x16x32_bf16 v[52:55], v[16:19], v[212:215], v[52:55]
  ds_read_b128 v[56:59], v62 offset:5120
  v_mfma_f32_16x16x32_bf16 v[44:47], v[16:19], v[164:167], v[44:47]
  v_mfma_f32_16x16x32_bf16 v[36:39], v[16:19], v[116:119], v[36:39]
  v_mfma_f32_16x16x32_bf16 v[28:31], v[16:19], v[68:71], v[28:31]
  s_waitcnt lgkmcnt(1)
  v_mfma_f32_16x16x32_bf16 v[24:27], v[20:23], v[72:75], v[24:27]
  ds_read_b128 v[16:19], v62 offset:6144
  v_mfma_f32_16x16x32_bf16 v[32:35], v[20:23], v[120:123], v[32:35]
  v_mfma_f32_16x16x32_bf16 v[40:43], v[20:23], v[168:171], v[40:43]
  v_mfma_f32_16x16x32_bf16 v[48:51], v[20:23], v[216:219], v[48:51]
  s_waitcnt lgkmcnt(1)
  v_mfma_f32_16x16x32_bf16 v[52:55], v[56:59], v[216:219], v[52:55]
  ds_read_b128 v[20:23], v62 offset:7168
  v_mfma_f32_16x16x32_bf16 v[44:47], v[56:59], v[168:171], v[44:47]
  v_mfma_f32_16x16x32_bf16 v[36:39], v[56:59], v[120:123], v[36:39]
  v_mfma_f32_16x16x32_bf16 v[28:31], v[56:59], v[72:75], v[28:31]
  s_waitcnt lgkmcnt(1)
  v_mfma_f32_16x16x32_bf16 v[24:27], v[16:19], v[76:79], v[24:27]
  ds_read_b128 v[56:59], v62 offset:8192
  v_mfma_f32_16x16x32_bf16 v[32:35], v[16:19], v[124:127], v[32:35]
  v_mfma_f32_16x16x32_bf16 v[40:43], v[16:19], v[172:175], v[40:43]
  v_mfma_f32_16x16x32_bf16 v[48:51], v[16:19], v[220:223], v[48:51]
  s_waitcnt lgkmcnt(1)
  v_mfma_f32_16x16x32_bf16 v[52:55], v[20:23], v[220:223], v[52:55]
  ds_read_b128 v[16:19], v62 offset:9216
  v_mfma_f32_16x16x32_bf16 v[44:47], v[20:23], v[172:175], v[44:47]
  v_mfma_f32_16x16x32_bf16 v[36:39], v[20:23], v[124:127], v[36:39]
  v_mfma_f32_16x16x32_bf16 v[28:31], v[20:23], v[76:79], v[28:31]
  s_waitcnt lgkmcnt(1)
  v_mfma_f32_16x16x32_bf16 v[24:27], v[56:59], v[80:83], v[24:27]
  ds_read_b128 v[20:23], v62 offset:10240
  v_mfma_f32_16x16x32_bf16 v[32:35], v[56:59], v[128:131], v[32:35]
  v_mfma_f32_16x16x32_bf16 v[40:43], v[56:59], v[176:179], v[40:43]
  v_mfma_f32_16x16x32_bf16 v[48:51], v[56:59], v[224:227], v[48:51]
  s_waitcnt lgkmcnt(1)
  v_mfma_f32_16x16x32_bf16 v[52:55], v[16:19], v[224:227], v[52:55]
  ds_read_b128 v[56:59], v62 offset:11264
  v_mfma_f32_16x16x32_bf16 v[44:47], v[16:19], v[176:179], v[44:47]
  v_mfma_f32_16x16x32_bf16 v[36:39], v[16:19], v[128:131], v[36:39]
  v_mfma_f32_16x16x32_bf16 v[28:31], v[16:19], v[80:83], v[28:31]
  s_waitcnt lgkmcnt(1)
  v_mfma_f32_16x16x32_bf16 v[24:27], v[20:23], v[84:87], v[24:27]
  ds_read_b128 v[16:19], v62 offset:12288
  v_mfma_f32_16x16x32_bf16 v[32:35], v[20:23], v[132:135], v[32:35]
  v_mfma_f32_16x16x32_bf16 v[40:43], v[20:23], v[180:183], v[40:43]
  v_mfma_f32_16x16x32_bf16 v[48:51], v[20:23], v[228:231], v[48:51]
  s_waitcnt lgkmcnt(1)
  v_mfma_f32_16x16x32_bf16 v[52:55], v[56:59], v[228:231], v[52:55]
  ds_read_b128 v[20:23], v62 offset:13312
  v_mfma_f32_16x16x32_bf16 v[44:47], v[56:59], v[180:183], v[44:47]
  v_mfma_f32_16x16x32_bf16 v[36:39], v[56:59], v[132:135], v[36:39]
  v_mfma_f32_16x16x32_bf16 v[28:31], v[56:59], v[84:87], v[28:31]
  s_waitcnt lgkmcnt(1)
  v_mfma_f32_16x16x32_bf16 v[24:27], v[16:19], v[88:91], v[24:27]
  ds_read_b128 v[56:59], v62 offset:14336
  v_mfma_f32_16x16x32_bf16 v[32:35], v[16:19], v[136:139], v[32:35]
  v_mfma_f32_16x16x32_bf16 v[40:43], v[16:19], v[184:187], v[40:43]
  v_mfma_f32_16x16x32_bf16 v[48:51], v[16:19], v[232:235], v[48:51]
  s_waitcnt lgkmcnt(1)
  v_mfma_f32_16x16x32_bf16 v[52:55], v[20:23], v[232:235], v[52:55]
  ds_read_b128 v[16:19], v62 offset:15360
  v_mfma_f32_16x16x32_bf16 v[44:47], v[20:23], v[184:187], v[44:47]
  v_mfma_f32_16x16x32_bf16 v[36:39], v[20:23], v[136:139], v[36:39]
  v_mfma_f32_16x16x32_bf16 v[28:31], v[20:23], v[88:91], v[28:31]
  s_waitcnt lgkmcnt(1)
  v_mfma_f32_16x16x32_bf16 v[24:27], v[56:59], v[92:95], v[24:27]
  ds_read_b128 v[20:23], v62 offset:16384
  v_mfma_f32_16x16x32_bf16 v[32:35], v[56:59], v[140:143], v[32:35]
  v_mfma_f32_16x16x32_bf16 v[40:43], v[56:59], v[188:191], v[40:43]
  v_mfma_f32_16x16x32_bf16 v[48:51], v[56:59], v[236:239], v[48:51]
  s_waitcnt lgkmcnt(1)
  v_mfma_f32_16x16x32_bf16 v[52:55], v[16:19], v[236:239], v[52:55]
  ds_read_b128 v[56:59], v62 offset:17408
  v_mfma_f32_16x16x32_bf16 v[44:47], v[16:19], v[188:191], v[44:47]
  v_mfma_f32_16x16x32_bf16 v[36:39], v[16:19], v[140:143], v[36:39]
  v_mfma_f32_16x16x32_bf16 v[28:31], v[16:19], v[92:95], v[28:31]
  s_waitcnt lgkmcnt(1)
  v_mfma_f32_16x16x32_bf16 v[24:27], v[20:23], v[96:99], v[24:27]
  ds_read_b128 v[16:19], v62 offset:18432
  v_mfma_f32_16x16x32_bf16 v[32:35], v[20:23], v[144:147], v[32:35]
  v_mfma_f32_16x16x32_bf16 v[40:43], v[20:23], v[192:195], v[40:43]
  v_mfma_f32_16x16x32_bf16 v[48:51], v[20:23], v[240:243], v[48:51]
  s_waitcnt lgkmcnt(1)
  v_mfma_f32_16x16x32_bf16 v[52:55], v[56:59], v[240:243], v[52:55]
  ds_read_b128 v[20:23], v62 offset:19456
  v_mfma_f32_16x16x32_bf16 v[44:47], v[56:59], v[192:195], v[44:47]
  v_mfma_f32_16x16x32_bf16 v[36:39], v[56:59], v[144:147], v[36:39]
  v_mfma_f32_16x16x32_bf16 v[28:31], v[56:59], v[96:99], v[28:31]
  s_waitcnt lgkmcnt(1)
  v_mfma_f32_16x16x32_bf16 v[24:27], v[16:19], v[100:103], v[24:27]
  ds_read_b128 v[56:59], v62 offset:20480
  v_mfma_f32_16x16x32_bf16 v[32:35], v[16:19], v[148:151], v[32:35]
  v_mfma_f32_16x16x32_bf16 v[40:43], v[16:19], v[196:199], v[40:43]
  v_mfma_f32_16x16x32_bf16 v[48:51], v[16:19], v[244:247], v[48:51]
  s_waitcnt lgkmcnt(1)
  v_mfma_f32_16x16x32_bf16 v[52:55], v[20:23], v[244:247], v[52:55]
  ds_read_b128 v[16:19], v62 offset:21504
  v_mfma_f32_16x16x32_bf16 v[44:47], v[20:23], v[196:199], v[44:47]
  v_mfma_f32_16x16x32_bf16 v[36:39], v[20:23], v[148:151], v[36:39]
  v_mfma_f32_16x16x32_bf16 v[28:31], v[20:23], v[100:103], v[28:31]
  s_waitcnt lgkmcnt(1)
  v_mfma_f32_16x16x32_bf16 v[24:27], v[56:59], v[104:107], v[24:27]
  ds_read_b128 v[20:23], v62 offset:22528
  v_mfma_f32_16x16x32_bf16 v[32:35], v[56:59], v[152:155], v[32:35]
  v_mfma_f32_16x16x32_bf16 v[40:43], v[56:59], v[200:203], v[40:43]
  v_mfma_f32_16x16x32_bf16 v[48:51], v[56:59], v[248:251], v[48:51]
  s_waitcnt lgkmcnt(1)
  v_mfma_f32_16x16x32_bf16 v[52:55], v[16:19], v[248:251], v[52:55]
  ds_read_b128 v[56:59], v62 offset:23552
  v_mfma_f32_16x16x32_bf16 v[44:47], v[16:19], v[200:203], v[44:47]
  v_mfma_f32_16x16x32_bf16 v[36:39], v[16:19], v[152:155], v[36:39]
  v_mfma_f32_16x16x32_bf16 v[28:31], v[16:19], v[104:107], v[28:31]
  s_waitcnt lgkmcnt(1)
  v_mfma_f32_16x16x32_bf16 v[24:27], v[20:23], v[108:111], v[24:27]
  v_mfma_f32_16x16x32_bf16 v[32:35], v[20:23], v[156:159], v[32:35]
  v_mfma_f32_16x16x32_bf16 v[40:43], v[20:23], v[204:207], v[40:43]
  v_mfma_f32_16x16x32_bf16 v[48:51], v[20:23], v[252:255], v[48:51]
  s_waitcnt lgkmcnt(0)
  v_mfma_f32_16x16x32_bf16 v[52:55], v[56:59], v[252:255], v[52:55]
  v_mfma_f32_16x16x32_bf16 v[44:47], v[56:59], v[204:207], v[44:47]
  v_mfma_f32_16x16x32_bf16 v[36:39], v[56:59], v[156:159], v[36:39]
  v_mfma_f32_16x16x32_bf16 v[28:31], v[56:59], v[108:111], v[28:31]
  s_cmp_lt_u32 s40, 4
  s_cbranch_scc1 L_RM1
  s_barrier
L_RM1:
  s_setprio 0
  s_nop 4
  s_waitcnt vmcnt(0)
  v_lshlrev_b32 v61, 16, v12
  v_add_f32 v48, v48, v61
  v_and_b32 v12, 0xffff0000, v12
  v_add_f32 v49, v49, v12
  v_cvt_pk_bf16_f32 v48, v48, v49
  v_lshlrev_b32 v61, 16, v13
  v_add_f32 v50, v50, v61
  v_and_b32 v13, 0xffff0000, v13
  v_add_f32 v51, v51, v13
  v_cvt_pk_bf16_f32 v49, v50, v51
  v_lshlrev_b32 v61, 16, v14
  v_add_f32 v52, v52, v61
  v_and_b32 v14, 0xffff0000, v14
  v_add_f32 v53, v53, v14
  v_cvt_pk_bf16_f32 v50, v52, v53
  v_lshlrev_b32 v61, 16, v15
  v_add_f32 v54, v54, v61
  v_and_b32 v15, 0xffff0000, v15
  v_add_f32 v55, v55, v15
  v_cvt_pk_bf16_f32 v51, v54, v55
  buffer_load_dwordx4 v[12:15], v60, s[4:7], s63 offen offset:256
  buffer_store_dwordx4 v[48:51], v60, s[8:11], s63 offen offset:0 sc1
  v_lshlrev_b32 v61, 16, v8
  v_add_f32 v40, v40, v61
  v_and_b32 v8, 0xffff0000, v8
  v_add_f32 v41, v41, v8
  v_cvt_pk_bf16_f32 v40, v40, v41
  v_lshlrev_b32 v61, 16, v9
  v_add_f32 v42, v42, v61
  v_and_b32 v9, 0xffff0000, v9
  v_add_f32 v43, v43, v9
  v_cvt_pk_bf16_f32 v41, v42, v43
  v_lshlrev_b32 v61, 16, v10
  v_add_f32 v44, v44, v61
  v_and_b32 v10, 0xffff0000, v10
  v_add_f32 v45, v45, v10
  v_cvt_pk_bf16_f32 v42, v44, v45
  v_lshlrev_b32 v61, 16, v11
  v_add_f32 v46, v46, v61
  v_and_b32 v11, 0xffff0000, v11
  v_add_f32 v47, v47, v11
  v_cvt_pk_bf16_f32 v43, v46, v47
  buffer_load_dwordx4 v[8:11], v60, s[4:7], s62 offen offset:256
  buffer_store_dwordx4 v[40:43], v60, s[8:11], s62 offen offset:0 sc1
  v_lshlrev_b32 v61, 16, v4
  v_add_f32 v32, v32, v61
  v_and_b32 v4, 0xffff0000, v4
  v_add_f32 v33, v33, v4
  v_cvt_pk_bf16_f32 v32, v32, v33
  v_lshlrev_b32 v61, 16, v5
  v_add_f32 v34, v34, v61
  v_and_b32 v5, 0xffff0000, v5
  v_add_f32 v35, v35, v5
  v_cvt_pk_bf16_f32 v33, v34, v35
  v_lshlrev_b32 v61, 16, v6
  v_add_f32 v36, v36, v61
  v_and_b32 v6, 0xffff0000, v6
  v_add_f32 v37, v37, v6
  v_cvt_pk_bf16_f32 v34, v36, v37
  v_lshlrev_b32 v61, 16, v7
  v_add_f32 v38, v38, v61
  v_and_b32 v7, 0xffff0000, v7
  v_add_f32 v39, v39, v7
  v_cvt_pk_bf16_f32 v35, v38, v39
  s_cmp_ge_u32 s40, 4
  s_cbranch_scc1 L_RMX0
  buffer_load_dwordx4 v[44:47], v60, s[4:7], s82 offen offset:192
L_RMX0:
  buffer_load_dwordx4 v[4:7], v60, s[4:7], s61 offen offset:256
  buffer_store_dwordx4 v[32:35], v60, s[8:11], s61 offen offset:0 sc1
  v_lshlrev_b32 v61, 16, v0
  v_add_f32 v24, v24, v61
  v_and_b32 v0, 0xffff0000, v0
  v_add_f32 v25, v25, v0
  v_cvt_pk_bf16_f32 v24, v24, v25
  v_lshlrev_b32 v61, 16, v1
  v_add_f32 v26, v26, v61
  v_and_b32 v1, 0xffff0000, v1
  v_add_f32 v27, v27, v1
  v_cvt_pk_bf16_f32 v25, v26, v27
  v_lshlrev_b32 v61, 16, v2
  v_add_f32 v28, v28, v61
  v_and_b32 v2, 0xffff0000, v2
  v_add_f32 v29, v29, v2
  v_cvt_pk_bf16_f32 v26, v28, v29
  v_lshlrev_b32 v61, 16, v3
  v_add_f32 v30, v30, v61
  v_and_b32 v3, 0xffff0000, v3
  v_add_f32 v31, v31, v3
  v_cvt_pk_bf16_f32 v27, v30, v31
  buffer_load_dwordx4 v[0:3], v60, s[4:7], s60 offen offset:256
  buffer_store_dwordx4 v[24:27], v60, s[8:11], s60 offen offset:0 sc1
  s_cmp_ge_u32 s40, 4
  s_cbranch_scc1 L_RMN0
  v_and_b32 v61, 0x30, v60
  v_lshl_add_u32 v61, v61, 1, s57
  v_xor_b32 v37, 32, v63
  v_add_u32 v37, 256, v37
  ds_read_b128 v[48:51], v61 offset:2048
  ds_read_b128 v[52:55], v61 offset:2064
  ds_read_b64_tr_b16 v[24:25], v63 offset:0
  ds_read_b64_tr_b16 v[26:27], v37 offset:0
  ds_read_b128 v[16:19], v62 offset:0
  ds_read_b128 v[20:23], v62 offset:1024
  ds_read_b64_tr_b16 v[28:29], v63 offset:2048
  ds_read_b64_tr_b16 v[30:31], v37 offset:2048
  ds_read_b128 v[56:59], v62 offset:2048
  s_setprio 3
  s_waitcnt lgkmcnt(4)
  v_mfma_f32_16x16x32_bf16 v[48:51], v[16:19], v[24:27], v[48:51]
  ds_read_b64_tr_b16 v[32:33], v63 offset:4096
  ds_read_b64_tr_b16 v[34:35], v37 offset:4096
  ds_read_b128 v[40:43], v62 offset:3072
  s_waitcnt lgkmcnt(6)
  v_mfma_f32_16x16x32_bf16 v[52:55], v[20:23], v[24:27], v[52:55]
  ds_read_b128 v[16:19], v62 offset:4096
  s_waitcnt lgkmcnt(4)
  v_mfma_f32_16x16x32_bf16 v[48:51], v[56:59], v[28:31], v[48:51]
  ds_read_b64_tr_b16 v[24:25], v63 offset:6144
  ds_read_b64_tr_b16 v[26:27], v37 offset:6144
  ds_read_b128 v[20:23], v62 offset:5120
  s_waitcnt lgkmcnt(4)
  v_mfma_f32_16x16x32_bf16 v[52:55], v[40:43], v[28:31], v[52:55]
  ds_read_b128 v[56:59], v62 offset:6144
  s_waitcnt lgkmcnt(4)
  v_mfma_f32_16x16x32_bf16 v[48:51], v[16:19], v[32:35], v[48:51]
  ds_read_b64_tr_b16 v[28:29], v63 offset:8192
  ds_read_b64_tr_b16 v[30:31], v37 offset:8192
  ds_read_b128 v[40:43], v62 offset:7168
  s_waitcnt lgkmcnt(4)
  v_mfma_f32_16x16x32_bf16 v[52:55], v[20:23], v[32:35], v[52:55]
  ds_read_b128 v[16:19], v62 offset:8192
  s_waitcnt lgkmcnt(4)
  v_mfma_f32_16x16x32_bf16 v[48:51], v[56:59], v[24:27], v[48:51]
  ds_read_b64_tr_b16 v[32:33], v63 offset:10240
  ds_read_b64_tr_b16 v[34:35], v37 offset:10240
  ds_read_b128 v[20:23], v62 offset:9216
  s_waitcnt lgkmcnt(4)
  v_mfma_f32_16x16x32_bf16 v[52:55], v[40:43], v[24:27], v[52:55]
  ds_read_b128 v[56:59], v62 offset:10240
  s_waitcnt lgkmcnt(4)
  v_mfma_f32_16x16x32_bf16 v[48:51], v[16:19], v[28:31], v[48:51]
  ds_read_b64_tr_b16 v[24:25], v63 offset:12288
  ds_read_b64_tr_b16 v[26:27], v37 offset:12288
  ds_read_b128 v[40:43], v62 offset:11264
  s_waitcnt lgkmcnt(4)
  v_mfma_f32_16x16x32_bf16 v[52:55], v[20:23], v[28:31], v[52:55]
  ds_read_b128 v[16:19], v62 offset:12288
  s_waitcnt lgkmcnt(4)
  v_mfma_f32_16x16x32_bf16 v[48:51], v[56:59], v[32:35], v[48:51]
  ds_read_b64_tr_b16 v[28:29], v63 offset:14336
  ds_read_b64_tr_b16 v[30:31], v37 offset:14336
  ds_read_b128 v[20:23], v62 offset:13312
  s_waitcnt lgkmcnt(4)
  v_mfma_f32_16x16x32_bf16 v[52:55], v[40:43], v[32:35], v[52:55]
  ds_read_b128 v[56:59], v62 offset:14336
  s_waitcnt lgkmcnt(4)
  v_mfma_f32_16x16x32_bf16 v[48:51], v[16:19], v[24:27], v[48:51]
  ds_read_b64_tr_b16 v[32:33], v63 offset:16384
  ds_read_b64_tr_b16 v[34:35], v37 offset:16384
  ds_read_b128 v[40:43], v62 offset:15360
  s_waitcnt lgkmcnt(4)
  v_mfma_f32_16x16x32_bf16 v[52:55], v[20:23], v[24:27], v[52:55]
  ds_read_b128 v[16:19], v62 offset:16384
  s_waitcnt lgkmcnt(4)
  v_mfma_f32_16x16x32_bf16 v[48:51], v[56:59], v[28:31], v[48:51]
  ds_read_b64_tr_b16 v[24:25], v63 offset:18432
  ds_read_b64_tr_b16 v[26:27], v37 offset:18432
  ds_read_b128 v[20:23], v62 offset:17408
  s_waitcnt lgkmcnt(4)
  v_mfma_f32_16x16x32_bf16 v[52:55], v[40:43], v[28:31], v[52:55]
  ds_read_b128 v[56:59], v62 offset:18432
  s_waitcnt lgkmcnt(4)
  v_mfma_f32_16x16x32_bf16 v[48:51], v[16:19], v[32:35], v[48:51]
  ds_read_b64_tr_b16 v[28:29], v63 offset:20480
  ds_read_b64_tr_b16 v[30:31], v37 offset:20480
  ds_read_b128 v[40:43], v62 offset:19456
  s_waitcnt lgkmcnt(4)
  v_mfma_f32_16x16x32_bf16 v[52:55], v[20:23], v[32:35], v[52:55]
  ds_read_b128 v[16:19], v62 offset:20480
  s_waitcnt lgkmcnt(4)
  v_mfma_f32_16x16x32_bf16 v[48:51], v[56:59], v[24:27], v[48:51]
  ds_read_b64_tr_b16 v[32:33], v63 offset:22528
  ds_read_b64_tr_b16 v[34:35], v37 offset:22528
  ds_read_b128 v[20:23], v62 offset:21504
  s_waitcnt lgkmcnt(4)
  v_mfma_f32_16x16x32_bf16 v[52:55], v[40:43], v[24:27], v[52:55]
  ds_read_b128 v[56:59], v62 offset:22528
  s_waitcnt lgkmcnt(4)
  v_mfma_f32_16x16x32_bf16 v[48:51], v[16:19], v[28:31], v[48:51]
  ds_read_b128 v[40:43], v62 offset:23552
  s_waitcnt lgkmcnt(2)
  v_mfma_f32_16x16x32_bf16 v[52:55], v[20:23], v[28:31], v[52:55]
  s_waitcnt lgkmcnt(1)
  v_mfma_f32_16x16x32_bf16 v[48:51], v[56:59], v[32:35], v[48:51]
  s_waitcnt lgkmcnt(0)
  v_mfma_f32_16x16x32_bf16 v[52:55], v[40:43], v[32:35], v[52:55]
  s_setprio 0
  s_nop 6
  s_waitcnt vmcnt(4)
  v_lshlrev_b32 v61, 16, v44
  v_add_f32 v48, v48, v61
  v_and_b32 v44, 0xffff0000, v44
  v_add_f32 v49, v49, v44
  v_cvt_pk_bf16_f32 v48, v48, v49
  v_lshlrev_b32 v61, 16, v45
  v_add_f32 v50, v50, v61
  v_and_b32 v45, 0xffff0000, v45
  v_add_f32 v51, v51, v45
  v_cvt_pk_bf16_f32 v49, v50, v51
  v_lshlrev_b32 v61, 16, v46
  v_add_f32 v52, v52, v61
  v_and_b32 v46, 0xffff0000, v46
  v_add_f32 v53, v53, v46
  v_cvt_pk_bf16_f32 v50, v52, v53
  v_lshlrev_b32 v61, 16, v47
  v_add_f32 v54, v54, v61
  v_and_b32 v47, 0xffff0000, v47
  v_add_f32 v55, v55, v47
  v_cvt_pk_bf16_f32 v51, v54, v55
  buffer_store_dwordx4 v[48:51], v60, s[8:11], s82 offen offset:0 sc1
  s_barrier
L_RMN0:
  v_and_b32 v61, 0x30, v60
  v_lshl_add_u32 v61, v61, 1, s57
  v_add_u32 v62, 0x00006000, v62
  ds_read_b128 v[24:27], v61 offset:2176
  ds_read_b128 v[28:31], v61 offset:2192
  ds_read_b128 v[32:35], v61 offset:2176
  ds_read_b128 v[36:39], v61 offset:2192
  ds_read_b128 v[40:43], v61 offset:2176
  ds_read_b128 v[44:47], v61 offset:2192
  ds_read_b128 v[48:51], v61 offset:2176
  ds_read_b128 v[52:55], v61 offset:2192
  ds_read_b128 v[16:19], v62 offset:0
  ds_read_b128 v[20:23], v62 offset:1024
  s_setprio 3
  s_waitcnt lgkmcnt(1)
  v_mfma_f32_16x16x32_bf16 v[24:27], v[16:19], v[64:67], v[24:27]
  ds_read_b128 v[56:59], v62 offset:2048
  v_mfma_f32_16x16x32_bf16 v[32:35], v[16:19], v[112:115], v[32:35]
  v_mfma_f32_16x16x32_bf16 v[40:43], v[16:19], v[160:163], v[40:43]
  v_mfma_f32_16x16x32_bf16 v[48:51], v[16:19], v[208:211], v[48:51]
  s_waitcnt lgkmcnt(1)
  v_mfma_f32_16x16x32_bf16 v[52:55], v[20:23], v[208:211], v[52:55]
  ds_read_b128 v[16:19], v62 offset:3072
  v_mfma_f32_16x16x32_bf16 v[44:47], v[20:23], v[160:163], v[44:47]
  v_mfma_f32_16x16x32_bf16 v[36:39], v[20:23], v[112:115], v[36:39]
  v_mfma_f32_16x16x32_bf16 v[28:31], v[20:23], v[64:67], v[28:31]
  s_waitcnt lgkmcnt(1)
  v_mfma_f32_16x16x32_bf16 v[24:27], v[56:59], v[68:71], v[24:27]
  ds_read_b128 v[20:23], v62 offset:4096
  v_mfma_f32_16x16x32_bf16 v[32:35], v[56:59], v[116:119], v[32:35]
  v_mfma_f32_16x16x32_bf16 v[40:43], v[56:59], v[164:167], v[40:43]
  v_mfma_f32_16x16x32_bf16 v[48:51], v[56:59], v[212:215], v[48:51]
  s_waitcnt lgkmcnt(1)
  v_mfma_f32_16x16x32_bf16 v[52:55], v[16:19], v[212:215], v[52:55]
  ds_read_b128 v[56:59], v62 offset:5120
  v_mfma_f32_16x16x32_bf16 v[44:47], v[16:19], v[164:167], v[44:47]
  v_mfma_f32_16x16x32_bf16 v[36:39], v[16:19], v[116:119], v[36:39]
  v_mfma_f32_16x16x32_bf16 v[28:31], v[16:19], v[68:71], v[28:31]
  s_waitcnt lgkmcnt(1)
  v_mfma_f32_16x16x32_bf16 v[24:27], v[20:23], v[72:75], v[24:27]
  ds_read_b128 v[16:19], v62 offset:6144
  v_mfma_f32_16x16x32_bf16 v[32:35], v[20:23], v[120:123], v[32:35]
  v_mfma_f32_16x16x32_bf16 v[40:43], v[20:23], v[168:171], v[40:43]
  v_mfma_f32_16x16x32_bf16 v[48:51], v[20:23], v[216:219], v[48:51]
  s_waitcnt lgkmcnt(1)
  v_mfma_f32_16x16x32_bf16 v[52:55], v[56:59], v[216:219], v[52:55]
  ds_read_b128 v[20:23], v62 offset:7168
  v_mfma_f32_16x16x32_bf16 v[44:47], v[56:59], v[168:171], v[44:47]
  v_mfma_f32_16x16x32_bf16 v[36:39], v[56:59], v[120:123], v[36:39]
  v_mfma_f32_16x16x32_bf16 v[28:31], v[56:59], v[72:75], v[28:31]
  s_waitcnt lgkmcnt(1)
  v_mfma_f32_16x16x32_bf16 v[24:27], v[16:19], v[76:79], v[24:27]
  ds_read_b128 v[56:59], v62 offset:8192
  v_mfma_f32_16x16x32_bf16 v[32:35], v[16:19], v[124:127], v[32:35]
  v_mfma_f32_16x16x32_bf16 v[40:43], v[16:19], v[172:175], v[40:43]
  v_mfma_f32_16x16x32_bf16 v[48:51], v[16:19], v[220:223], v[48:51]
  s_waitcnt lgkmcnt(1)
  v_mfma_f32_16x16x32_bf16 v[52:55], v[20:23], v[220:223], v[52:55]
  ds_read_b128 v[16:19], v62 offset:9216
  v_mfma_f32_16x16x32_bf16 v[44:47], v[20:23], v[172:175], v[44:47]
  v_mfma_f32_16x16x32_bf16 v[36:39], v[20:23], v[124:127], v[36:39]
  v_mfma_f32_16x16x32_bf16 v[28:31], v[20:23], v[76:79], v[28:31]
  s_waitcnt lgkmcnt(1)
  v_mfma_f32_16x16x32_bf16 v[24:27], v[56:59], v[80:83], v[24:27]
  ds_read_b128 v[20:23], v62 offset:10240
  v_mfma_f32_16x16x32_bf16 v[32:35], v[56:59], v[128:131], v[32:35]
  v_mfma_f32_16x16x32_bf16 v[40:43], v[56:59], v[176:179], v[40:43]
  v_mfma_f32_16x16x32_bf16 v[48:51], v[56:59], v[224:227], v[48:51]
  s_waitcnt lgkmcnt(1)
  v_mfma_f32_16x16x32_bf16 v[52:55], v[16:19], v[224:227], v[52:55]
  ds_read_b128 v[56:59], v62 offset:11264
  v_mfma_f32_16x16x32_bf16 v[44:47], v[16:19], v[176:179], v[44:47]
  v_mfma_f32_16x16x32_bf16 v[36:39], v[16:19], v[128:131], v[36:39]
  v_mfma_f32_16x16x32_bf16 v[28:31], v[16:19], v[80:83], v[28:31]
  s_waitcnt lgkmcnt(1)
  v_mfma_f32_16x16x32_bf16 v[24:27], v[20:23], v[84:87], v[24:27]
  ds_read_b128 v[16:19], v62 offset:12288
  v_mfma_f32_16x16x32_bf16 v[32:35], v[20:23], v[132:135], v[32:35]
  v_mfma_f32_16x16x32_bf16 v[40:43], v[20:23], v[180:183], v[40:43]
  v_mfma_f32_16x16x32_bf16 v[48:51], v[20:23], v[228:231], v[48:51]
  s_waitcnt lgkmcnt(1)
  v_mfma_f32_16x16x32_bf16 v[52:55], v[56:59], v[228:231], v[52:55]
  ds_read_b128 v[20:23], v62 offset:13312
  v_mfma_f32_16x16x32_bf16 v[44:47], v[56:59], v[180:183], v[44:47]
  v_mfma_f32_16x16x32_bf16 v[36:39], v[56:59], v[132:135], v[36:39]
  v_mfma_f32_16x16x32_bf16 v[28:31], v[56:59], v[84:87], v[28:31]
  s_waitcnt lgkmcnt(1)
  v_mfma_f32_16x16x32_bf16 v[24:27], v[16:19], v[88:91], v[24:27]
  ds_read_b128 v[56:59], v62 offset:14336
  v_mfma_f32_16x16x32_bf16 v[32:35], v[16:19], v[136:139], v[32:35]
  v_mfma_f32_16x16x32_bf16 v[40:43], v[16:19], v[184:187], v[40:43]
  v_mfma_f32_16x16x32_bf16 v[48:51], v[16:19], v[232:235], v[48:51]
  s_waitcnt lgkmcnt(1)
  v_mfma_f32_16x16x32_bf16 v[52:55], v[20:23], v[232:235], v[52:55]
  ds_read_b128 v[16:19], v62 offset:15360
  v_mfma_f32_16x16x32_bf16 v[44:47], v[20:23], v[184:187], v[44:47]
  v_mfma_f32_16x16x32_bf16 v[36:39], v[20:23], v[136:139], v[36:39]
  v_mfma_f32_16x16x32_bf16 v[28:31], v[20:23], v[88:91], v[28:31]
  s_waitcnt lgkmcnt(1)
  v_mfma_f32_16x16x32_bf16 v[24:27], v[56:59], v[92:95], v[24:27]
  ds_read_b128 v[20:23], v62 offset:16384
  v_mfma_f32_16x16x32_bf16 v[32:35], v[56:59], v[140:143], v[32:35]
  v_mfma_f32_16x16x32_bf16 v[40:43], v[56:59], v[188:191], v[40:43]
  v_mfma_f32_16x16x32_bf16 v[48:51], v[56:59], v[236:239], v[48:51]
  s_waitcnt lgkmcnt(1)
  v_mfma_f32_16x16x32_bf16 v[52:55], v[16:19], v[236:239], v[52:55]
  ds_read_b128 v[56:59], v62 offset:17408
  v_mfma_f32_16x16x32_bf16 v[44:47], v[16:19], v[188:191], v[44:47]
  v_mfma_f32_16x16x32_bf16 v[36:39], v[16:19], v[140:143], v[36:39]
  v_mfma_f32_16x16x32_bf16 v[28:31], v[16:19], v[92:95], v[28:31]
  s_waitcnt lgkmcnt(1)
  v_mfma_f32_16x16x32_bf16 v[24:27], v[20:23], v[96:99], v[24:27]
  ds_read_b128 v[16:19], v62 offset:18432
  v_mfma_f32_16x16x32_bf16 v[32:35], v[20:23], v[144:147], v[32:35]
  v_mfma_f32_16x16x32_bf16 v[40:43], v[20:23], v[192:195], v[40:43]
  v_mfma_f32_16x16x32_bf16 v[48:51], v[20:23], v[240:243], v[48:51]
  s_waitcnt lgkmcnt(1)
  v_mfma_f32_16x16x32_bf16 v[52:55], v[56:59], v[240:243], v[52:55]
  ds_read_b128 v[20:23], v62 offset:19456
  v_mfma_f32_16x16x32_bf16 v[44:47], v[56:59], v[192:195], v[44:47]
  v_mfma_f32_16x16x32_bf16 v[36:39], v[56:59], v[144:147], v[36:39]
  v_mfma_f32_16x16x32_bf16 v[28:31], v[56:59], v[96:99], v[28:31]
  s_waitcnt lgkmcnt(1)
  v_mfma_f32_16x16x32_bf16 v[24:27], v[16:19], v[100:103], v[24:27]
  ds_read_b128 v[56:59], v62 offset:20480
  v_mfma_f32_16x16x32_bf16 v[32:35], v[16:19], v[148:151], v[32:35]
  v_mfma_f32_16x16x32_bf16 v[40:43], v[16:19], v[196:199], v[40:43]
  v_mfma_f32_16x16x32_bf16 v[48:51], v[16:19], v[244:247], v[48:51]
  s_waitcnt lgkmcnt(1)
  v_mfma_f32_16x16x32_bf16 v[52:55], v[20:23], v[244:247], v[52:55]
  ds_read_b128 v[16:19], v62 offset:21504
  v_mfma_f32_16x16x32_bf16 v[44:47], v[20:23], v[196:199], v[44:47]
  v_mfma_f32_16x16x32_bf16 v[36:39], v[20:23], v[148:151], v[36:39]
  v_mfma_f32_16x16x32_bf16 v[28:31], v[20:23], v[100:103], v[28:31]
  s_waitcnt lgkmcnt(1)
  v_mfma_f32_16x16x32_bf16 v[24:27], v[56:59], v[104:107], v[24:27]
  ds_read_b128 v[20:23], v62 offset:22528
  v_mfma_f32_16x16x32_bf16 v[32:35], v[56:59], v[152:155], v[32:35]
  v_mfma_f32_16x16x32_bf16 v[40:43], v[56:59], v[200:203], v[40:43]
  v_mfma_f32_16x16x32_bf16 v[48:51], v[56:59], v[248:251], v[48:51]
  s_waitcnt lgkmcnt(1)
  v_mfma_f32_16x16x32_bf16 v[52:55], v[16:19], v[248:251], v[52:55]
  ds_read_b128 v[56:59], v62 offset:23552
  v_mfma_f32_16x16x32_bf16 v[44:47], v[16:19], v[200:203], v[44:47]
  v_mfma_f32_16x16x32_bf16 v[36:39], v[16:19], v[152:155], v[36:39]
  v_mfma_f32_16x16x32_bf16 v[28:31], v[16:19], v[104:107], v[28:31]
  s_waitcnt lgkmcnt(1)
  v_mfma_f32_16x16x32_bf16 v[24:27], v[20:23], v[108:111], v[24:27]
  v_mfma_f32_16x16x32_bf16 v[32:35], v[20:23], v[156:159], v[32:35]
  v_mfma_f32_16x16x32_bf16 v[40:43], v[20:23], v[204:207], v[40:43]
  v_mfma_f32_16x16x32_bf16 v[48:51], v[20:23], v[252:255], v[48:51]
  s_waitcnt lgkmcnt(0)
  v_mfma_f32_16x16x32_bf16 v[52:55], v[56:59], v[252:255], v[52:55]
  v_mfma_f32_16x16x32_bf16 v[44:47], v[56:59], v[204:207], v[44:47]
  v_mfma_f32_16x16x32_bf16 v[36:39], v[56:59], v[156:159], v[36:39]
  v_mfma_f32_16x16x32_bf16 v[28:31], v[56:59], v[108:111], v[28:31]
  s_setprio 0
  s_nop 4
  s_waitcnt vmcnt(1)
  v_lshlrev_b32 v61, 16, v12
  v_add_f32 v48, v48, v61
  v_and_b32 v12, 0xffff0000, v12
  v_add_f32 v49, v49, v12
  v_cvt_pk_bf16_f32 v48, v48, v49
  v_lshlrev_b32 v61, 16, v13
  v_add_f32 v50, v50, v61
  v_and_b32 v13, 0xffff0000, v13
  v_add_f32 v51, v51, v13
  v_cvt_pk_bf16_f32 v49, v50, v51
  v_lshlrev_b32 v61, 16, v14
  v_add_f32 v52, v52, v61
  v_and_b32 v14, 0xffff0000, v14
  v_add_f32 v53, v53, v14
  v_cvt_pk_bf16_f32 v50, v52, v53
  v_lshlrev_b32 v61, 16, v15
  v_add_f32 v54, v54, v61
  v_and_b32 v15, 0xffff0000, v15
  v_add_f32 v55, v55, v15
  v_cvt_pk_bf16_f32 v51, v54, v55
  buffer_load_dwordx4 v[12:15], v60, s[4:7], s63 offen offset:320
  buffer_store_dwordx4 v[48:51], v60, s[8:11], s63 offen offset:64 sc1
  v_lshlrev_b32 v61, 16, v8
  v_add_f32 v40, v40, v61
  v_and_b32 v8, 0xffff0000, v8
  v_add_f32 v41, v41, v8
  v_cvt_pk_bf16_f32 v40, v40, v41
  v_lshlrev_b32 v61, 16, v9
  v_add_f32 v42, v42, v61
  v_and_b32 v9, 0xffff0000, v9
  v_add_f32 v43, v43, v9
  v_cvt_pk_bf16_f32 v41, v42, v43
  v_lshlrev_b32 v61, 16, v10
  v_add_f32 v44, v44, v61
  v_and_b32 v10, 0xffff0000, v10
  v_add_f32 v45, v45, v10
  v_cvt_pk_bf16_f32 v42, v44, v45
  v_lshlrev_b32 v61, 16, v11
  v_add_f32 v46, v46, v61
  v_and_b32 v11, 0xffff0000, v11
  v_add_f32 v47, v47, v11
  v_cvt_pk_bf16_f32 v43, v46, v47
  buffer_load_dwordx4 v[8:11], v60, s[4:7], s62 offen offset:320
  buffer_store_dwordx4 v[40:43], v60, s[8:11], s62 offen offset:64 sc1
  v_lshlrev_b32 v61, 16, v4
  v_add_f32 v32, v32, v61
  v_and_b32 v4, 0xffff0000, v4
  v_add_f32 v33, v33, v4
  v_cvt_pk_bf16_f32 v32, v32, v33
  v_lshlrev_b32 v61, 16, v5
  v_add_f32 v34, v34, v61
  v_and_b32 v5, 0xffff0000, v5
  v_add_f32 v35, v35, v5
  v_cvt_pk_bf16_f32 v33, v34, v35
  v_lshlrev_b32 v61, 16, v6
  v_add_f32 v36, v36, v61
  v_and_b32 v6, 0xffff0000, v6
  v_add_f32 v37, v37, v6
  v_cvt_pk_bf16_f32 v34, v36, v37
  v_lshlrev_b32 v61, 16, v7
  v_add_f32 v38, v38, v61
  v_and_b32 v7, 0xffff0000, v7
  v_add_f32 v39, v39, v7
  v_cvt_pk_bf16_f32 v35, v38, v39
  s_cmp_ge_u32 s40, 4
  s_cbranch_scc1 L_RMX1
  buffer_load_dwordx4 v[44:47], v60, s[4:7], s82 offen offset:256
L_RMX1:
  buffer_load_dwordx4 v[4:7], v60, s[4:7], s61 offen offset:320
  buffer_store_dwordx4 v[32:35], v60, s[8:11], s61 offen offset:64 sc1
  v_lshlrev_b32 v61, 16, v0
  v_add_f32 v24, v24, v61
  v_and_b32 v0, 0xffff0000, v0
  v_add_f32 v25, v25, v0
  v_cvt_pk_bf16_f32 v24, v24, v25
  v_lshlrev_b32 v61, 16, v1
  v_add_f32 v26, v26, v61
  v_and_b32 v1, 0xffff0000, v1
  v_add_f32 v27, v27, v1
  v_cvt_pk_bf16_f32 v25, v26, v27
  v_lshlrev_b32 v61, 16, v2
  v_add_f32 v28, v28, v61
  v_and_b32 v2, 0xffff0000, v2
  v_add_f32 v29, v29, v2
  v_cvt_pk_bf16_f32 v26, v28, v29
  v_lshlrev_b32 v61, 16, v3
  v_add_f32 v30, v30, v61
  v_and_b32 v3, 0xffff0000, v3
  v_add_f32 v31, v31, v3
  v_cvt_pk_bf16_f32 v27, v30, v31
  buffer_load_dwordx4 v[0:3], v60, s[4:7], s60 offen offset:320
  buffer_store_dwordx4 v[24:27], v60, s[8:11], s60 offen offset:64 sc1
  s_cmp_ge_u32 s40, 4
  s_cbranch_scc1 L_RMN1
  v_and_b32 v61, 0x30, v60
  v_lshl_add_u32 v61, v61, 1, s57
  v_xor_b32 v37, 32, v63
  v_add_u32 v37, 256, v37
  ds_read_b128 v[48:51], v61 offset:2176
  ds_read_b128 v[52:55], v61 offset:2192
  ds_read_b64_tr_b16 v[24:25], v63 offset:0
  ds_read_b64_tr_b16 v[26:27], v37 offset:0
  ds_read_b128 v[16:19], v62 offset:0
  ds_read_b128 v[20:23], v62 offset:1024
  ds_read_b64_tr_b16 v[28:29], v63 offset:2048
  ds_read_b64_tr_b16 v[30:31], v37 offset:2048
  ds_read_b128 v[56:59], v62 offset:2048
  s_setprio 3
  s_waitcnt lgkmcnt(4)
  v_mfma_f32_16x16x32_bf16 v[48:51], v[16:19], v[24:27], v[48:51]
  ds_read_b64_tr_b16 v[32:33], v63 offset:4096
  ds_read_b64_tr_b16 v[34:35], v37 offset:4096
  ds_read_b128 v[40:43], v62 offset:3072
  s_waitcnt lgkmcnt(6)
  v_mfma_f32_16x16x32_bf16 v[52:55], v[20:23], v[24:27], v[52:55]
  ds_read_b128 v[16:19], v62 offset:4096
  s_waitcnt lgkmcnt(4)
  v_mfma_f32_16x16x32_bf16 v[48:51], v[56:59], v[28:31], v[48:51]
  ds_read_b64_tr_b16 v[24:25], v63 offset:6144
  ds_read_b64_tr_b16 v[26:27], v37 offset:6144
  ds_read_b128 v[20:23], v62 offset:5120
  s_waitcnt lgkmcnt(4)
  v_mfma_f32_16x16x32_bf16 v[52:55], v[40:43], v[28:31], v[52:55]
  ds_read_b128 v[56:59], v62 offset:6144
  s_waitcnt lgkmcnt(4)
  v_mfma_f32_16x16x32_bf16 v[48:51], v[16:19], v[32:35], v[48:51]
  ds_read_b64_tr_b16 v[28:29], v63 offset:8192
  ds_read_b64_tr_b16 v[30:31], v37 offset:8192
  ds_read_b128 v[40:43], v62 offset:7168
  s_waitcnt lgkmcnt(4)
  v_mfma_f32_16x16x32_bf16 v[52:55], v[20:23], v[32:35], v[52:55]
  ds_read_b128 v[16:19], v62 offset:8192
  s_waitcnt lgkmcnt(4)
  v_mfma_f32_16x16x32_bf16 v[48:51], v[56:59], v[24:27], v[48:51]
  ds_read_b64_tr_b16 v[32:33], v63 offset:10240
  ds_read_b64_tr_b16 v[34:35], v37 offset:10240
  ds_read_b128 v[20:23], v62 offset:9216
  s_waitcnt lgkmcnt(4)
  v_mfma_f32_16x16x32_bf16 v[52:55], v[40:43], v[24:27], v[52:55]
  ds_read_b128 v[56:59], v62 offset:10240
  s_waitcnt lgkmcnt(4)
  v_mfma_f32_16x16x32_bf16 v[48:51], v[16:19], v[28:31], v[48:51]
  ds_read_b64_tr_b16 v[24:25], v63 offset:12288
  ds_read_b64_tr_b16 v[26:27], v37 offset:12288
  ds_read_b128 v[40:43], v62 offset:11264
  s_waitcnt lgkmcnt(4)
  v_mfma_f32_16x16x32_bf16 v[52:55], v[20:23], v[28:31], v[52:55]
  ds_read_b128 v[16:19], v62 offset:12288
  s_waitcnt lgkmcnt(4)
  v_mfma_f32_16x16x32_bf16 v[48:51], v[56:59], v[32:35], v[48:51]
  ds_read_b64_tr_b16 v[28:29], v63 offset:14336
  ds_read_b64_tr_b16 v[30:31], v37 offset:14336
  ds_read_b128 v[20:23], v62 offset:13312
  s_waitcnt lgkmcnt(4)
  v_mfma_f32_16x16x32_bf16 v[52:55], v[40:43], v[32:35], v[52:55]
  ds_read_b128 v[56:59], v62 offset:14336
  s_waitcnt lgkmcnt(4)
  v_mfma_f32_16x16x32_bf16 v[48:51], v[16:19], v[24:27], v[48:51]
  ds_read_b64_tr_b16 v[32:33], v63 offset:16384
  ds_read_b64_tr_b16 v[34:35], v37 offset:16384
  ds_read_b128 v[40:43], v62 offset:15360
  s_waitcnt lgkmcnt(4)
  v_mfma_f32_16x16x32_bf16 v[52:55], v[20:23], v[24:27], v[52:55]
  ds_read_b128 v[16:19], v62 offset:16384
  s_waitcnt lgkmcnt(4)
  v_mfma_f32_16x16x32_bf16 v[48:51], v[56:59], v[28:31], v[48:51]
  ds_read_b64_tr_b16 v[24:25], v63 offset:18432
  ds_read_b64_tr_b16 v[26:27], v37 offset:18432
  ds_read_b128 v[20:23], v62 offset:17408
  s_waitcnt lgkmcnt(4)
  v_mfma_f32_16x16x32_bf16 v[52:55], v[40:43], v[28:31], v[52:55]
  ds_read_b128 v[56:59], v62 offset:18432
  s_waitcnt lgkmcnt(4)
  v_mfma_f32_16x16x32_bf16 v[48:51], v[16:19], v[32:35], v[48:51]
  ds_read_b64_tr_b16 v[28:29], v63 offset:20480
  ds_read_b64_tr_b16 v[30:31], v37 offset:20480
  ds_read_b128 v[40:43], v62 offset:19456
  s_waitcnt lgkmcnt(4)
  v_mfma_f32_16x16x32_bf16 v[52:55], v[20:23], v[32:35], v[52:55]
  ds_read_b128 v[16:19], v62 offset:20480
  s_waitcnt lgkmcnt(4)
  v_mfma_f32_16x16x32_bf16 v[48:51], v[56:59], v[24:27], v[48:51]
  ds_read_b64_tr_b16 v[32:33], v63 offset:22528
  ds_read_b64_tr_b16 v[34:35], v37 offset:22528
  ds_read_b128 v[20:23], v62 offset:21504
  s_waitcnt lgkmcnt(4)
  v_mfma_f32_16x16x32_bf16 v[52:55], v[40:43], v[24:27], v[52:55]
  ds_read_b128 v[56:59], v62 offset:22528
  s_waitcnt lgkmcnt(4)
  v_mfma_f32_16x16x32_bf16 v[48:51], v[16:19], v[28:31], v[48:51]
  ds_read_b128 v[40:43], v62 offset:23552
  s_waitcnt lgkmcnt(2)
  v_mfma_f32_16x16x32_bf16 v[52:55], v[20:23], v[28:31], v[52:55]
  s_waitcnt lgkmcnt(1)
  v_mfma_f32_16x16x32_bf16 v[48:51], v[56:59], v[32:35], v[48:51]
  s_waitcnt lgkmcnt(0)
  v_mfma_f32_16x16x32_bf16 v[52:55], v[40:43], v[32:35], v[52:55]
  s_setprio 0
  s_nop 6
  s_waitcnt vmcnt(4)
  v_lshlrev_b32 v61, 16, v44
  v_add_f32 v48, v48, v61
  v_and_b32 v44, 0xffff0000, v44
  v_add_f32 v49, v49, v44
  v_cvt_pk_bf16_f32 v48, v48, v49
  v_lshlrev_b32 v61, 16, v45
  v_add_f32 v50, v50, v61
  v_and_b32 v45, 0xffff0000, v45
  v_add_f32 v51, v51, v45
  v_cvt_pk_bf16_f32 v49, v50, v51
  v_lshlrev_b32 v61, 16, v46
  v_add_f32 v52, v52, v61
  v_and_b32 v46, 0xffff0000, v46
  v_add_f32 v53, v53, v46
  v_cvt_pk_bf16_f32 v50, v52, v53
  v_lshlrev_b32 v61, 16, v47
  v_add_f32 v54, v54, v61
  v_and_b32 v47, 0xffff0000, v47
  v_add_f32 v55, v55, v47
  v_cvt_pk_bf16_f32 v51, v54, v55
  buffer_store_dwordx4 v[48:51], v60, s[8:11], s82 offen offset:64 sc1
L_RMN1:
  v_and_b32 v61, 0x30, v60
  v_lshl_add_u32 v61, v61, 1, s57
  v_add_u32 v62, 0x00006000, v62
  ds_read_b128 v[24:27], v61 offset:2304
  ds_read_b128 v[28:31], v61 offset:2320
  ds_read_b128 v[32:35], v61 offset:2304
  ds_read_b128 v[36:39], v61 offset:2320
  ds_read_b128 v[40:43], v61 offset:2304
  ds_read_b128 v[44:47], v61 offset:2320
  ds_read_b128 v[48:51], v61 offset:2304
  ds_read_b128 v[52:55], v61 offset:2320
  ds_read_b128 v[16:19], v62 offset:0
  ds_read_b128 v[20:23], v62 offset:1024
  s_setprio 3
  s_waitcnt lgkmcnt(1)
  v_mfma_f32_16x16x32_bf16 v[24:27], v[16:19], v[64:67], v[24:27]
  ds_read_b128 v[56:59], v62 offset:2048
  v_mfma_f32_16x16x32_bf16 v[32:35], v[16:19], v[112:115], v[32:35]
  v_mfma_f32_16x16x32_bf16 v[40:43], v[16:19], v[160:163], v[40:43]
  v_mfma_f32_16x16x32_bf16 v[48:51], v[16:19], v[208:211], v[48:51]
  s_waitcnt lgkmcnt(1)
  v_mfma_f32_16x16x32_bf16 v[52:55], v[20:23], v[208:211], v[52:55]
  ds_read_b128 v[16:19], v62 offset:3072
  v_mfma_f32_16x16x32_bf16 v[44:47], v[20:23], v[160:163], v[44:47]
  v_mfma_f32_16x16x32_bf16 v[36:39], v[20:23], v[112:115], v[36:39]
  v_mfma_f32_16x16x32_bf16 v[28:31], v[20:23], v[64:67], v[28:31]
  s_waitcnt lgkmcnt(1)
  v_mfma_f32_16x16x32_bf16 v[24:27], v[56:59], v[68:71], v[24:27]
  ds_read_b128 v[20:23], v62 offset:4096
  v_mfma_f32_16x16x32_bf16 v[32:35], v[56:59], v[116:119], v[32:35]
  v_mfma_f32_16x16x32_bf16 v[40:43], v[56:59], v[164:167], v[40:43]
  v_mfma_f32_16x16x32_bf16 v[48:51], v[56:59], v[212:215], v[48:51]
  s_waitcnt lgkmcnt(1)
  v_mfma_f32_16x16x32_bf16 v[52:55], v[16:19], v[212:215], v[52:55]
  ds_read_b128 v[56:59], v62 offset:5120
  v_mfma_f32_16x16x32_bf16 v[44:47], v[16:19], v[164:167], v[44:47]
  v_mfma_f32_16x16x32_bf16 v[36:39], v[16:19], v[116:119], v[36:39]
  v_mfma_f32_16x16x32_bf16 v[28:31], v[16:19], v[68:71], v[28:31]
  s_waitcnt lgkmcnt(1)
  v_mfma_f32_16x16x32_bf16 v[24:27], v[20:23], v[72:75], v[24:27]
  ds_read_b128 v[16:19], v62 offset:6144
  v_mfma_f32_16x16x32_bf16 v[32:35], v[20:23], v[120:123], v[32:35]
  v_mfma_f32_16x16x32_bf16 v[40:43], v[20:23], v[168:171], v[40:43]
  v_mfma_f32_16x16x32_bf16 v[48:51], v[20:23], v[216:219], v[48:51]
  s_waitcnt lgkmcnt(1)
  v_mfma_f32_16x16x32_bf16 v[52:55], v[56:59], v[216:219], v[52:55]
  ds_read_b128 v[20:23], v62 offset:7168
  v_mfma_f32_16x16x32_bf16 v[44:47], v[56:59], v[168:171], v[44:47]
  v_mfma_f32_16x16x32_bf16 v[36:39], v[56:59], v[120:123], v[36:39]
  v_mfma_f32_16x16x32_bf16 v[28:31], v[56:59], v[72:75], v[28:31]
  s_waitcnt lgkmcnt(1)
  v_mfma_f32_16x16x32_bf16 v[24:27], v[16:19], v[76:79], v[24:27]
  ds_read_b128 v[56:59], v62 offset:8192
  v_mfma_f32_16x16x32_bf16 v[32:35], v[16:19], v[124:127], v[32:35]
  v_mfma_f32_16x16x32_bf16 v[40:43], v[16:19], v[172:175], v[40:43]
  v_mfma_f32_16x16x32_bf16 v[48:51], v[16:19], v[220:223], v[48:51]
  s_waitcnt lgkmcnt(1)
  v_mfma_f32_16x16x32_bf16 v[52:55], v[20:23], v[220:223], v[52:55]
  ds_read_b128 v[16:19], v62 offset:9216
  v_mfma_f32_16x16x32_bf16 v[44:47], v[20:23], v[172:175], v[44:47]
  v_mfma_f32_16x16x32_bf16 v[36:39], v[20:23], v[124:127], v[36:39]
  v_mfma_f32_16x16x32_bf16 v[28:31], v[20:23], v[76:79], v[28:31]
  s_waitcnt lgkmcnt(1)
  v_mfma_f32_16x16x32_bf16 v[24:27], v[56:59], v[80:83], v[24:27]
  ds_read_b128 v[20:23], v62 offset:10240
  v_mfma_f32_16x16x32_bf16 v[32:35], v[56:59], v[128:131], v[32:35]
  v_mfma_f32_16x16x32_bf16 v[40:43], v[56:59], v[176:179], v[40:43]
  v_mfma_f32_16x16x32_bf16 v[48:51], v[56:59], v[224:227], v[48:51]
  s_waitcnt lgkmcnt(1)
  v_mfma_f32_16x16x32_bf16 v[52:55], v[16:19], v[224:227], v[52:55]
  ds_read_b128 v[56:59], v62 offset:11264
  v_mfma_f32_16x16x32_bf16 v[44:47], v[16:19], v[176:179], v[44:47]
  v_mfma_f32_16x16x32_bf16 v[36:39], v[16:19], v[128:131], v[36:39]
  v_mfma_f32_16x16x32_bf16 v[28:31], v[16:19], v[80:83], v[28:31]
  s_waitcnt lgkmcnt(1)
  v_mfma_f32_16x16x32_bf16 v[24:27], v[20:23], v[84:87], v[24:27]
  ds_read_b128 v[16:19], v62 offset:12288
  v_mfma_f32_16x16x32_bf16 v[32:35], v[20:23], v[132:135], v[32:35]
  v_mfma_f32_16x16x32_bf16 v[40:43], v[20:23], v[180:183], v[40:43]
  v_mfma_f32_16x16x32_bf16 v[48:51], v[20:23], v[228:231], v[48:51]
  s_waitcnt lgkmcnt(1)
  v_mfma_f32_16x16x32_bf16 v[52:55], v[56:59], v[228:231], v[52:55]
  ds_read_b128 v[20:23], v62 offset:13312
  v_mfma_f32_16x16x32_bf16 v[44:47], v[56:59], v[180:183], v[44:47]
  v_mfma_f32_16x16x32_bf16 v[36:39], v[56:59], v[132:135], v[36:39]
  v_mfma_f32_16x16x32_bf16 v[28:31], v[56:59], v[84:87], v[28:31]
  s_waitcnt lgkmcnt(1)
  v_mfma_f32_16x16x32_bf16 v[24:27], v[16:19], v[88:91], v[24:27]
  ds_read_b128 v[56:59], v62 offset:14336
  v_mfma_f32_16x16x32_bf16 v[32:35], v[16:19], v[136:139], v[32:35]
  v_mfma_f32_16x16x32_bf16 v[40:43], v[16:19], v[184:187], v[40:43]
  v_mfma_f32_16x16x32_bf16 v[48:51], v[16:19], v[232:235], v[48:51]
  s_waitcnt lgkmcnt(1)
  v_mfma_f32_16x16x32_bf16 v[52:55], v[20:23], v[232:235], v[52:55]
  ds_read_b128 v[16:19], v62 offset:15360
  v_mfma_f32_16x16x32_bf16 v[44:47], v[20:23], v[184:187], v[44:47]
  v_mfma_f32_16x16x32_bf16 v[36:39], v[20:23], v[136:139], v[36:39]
  v_mfma_f32_16x16x32_bf16 v[28:31], v[20:23], v[88:91], v[28:31]
  s_waitcnt lgkmcnt(1)
  v_mfma_f32_16x16x32_bf16 v[24:27], v[56:59], v[92:95], v[24:27]
  ds_read_b128 v[20:23], v62 offset:16384
  v_mfma_f32_16x16x32_bf16 v[32:35], v[56:59], v[140:143], v[32:35]
  v_mfma_f32_16x16x32_bf16 v[40:43], v[56:59], v[188:191], v[40:43]
  v_mfma_f32_16x16x32_bf16 v[48:51], v[56:59], v[236:239], v[48:51]
  s_waitcnt lgkmcnt(1)
  v_mfma_f32_16x16x32_bf16 v[52:55], v[16:19], v[236:239], v[52:55]
  ds_read_b128 v[56:59], v62 offset:17408
  v_mfma_f32_16x16x32_bf16 v[44:47], v[16:19], v[188:191], v[44:47]
  v_mfma_f32_16x16x32_bf16 v[36:39], v[16:19], v[140:143], v[36:39]
  v_mfma_f32_16x16x32_bf16 v[28:31], v[16:19], v[92:95], v[28:31]
  s_waitcnt lgkmcnt(1)
  v_mfma_f32_16x16x32_bf16 v[24:27], v[20:23], v[96:99], v[24:27]
  ds_read_b128 v[16:19], v62 offset:18432
  v_mfma_f32_16x16x32_bf16 v[32:35], v[20:23], v[144:147], v[32:35]
  v_mfma_f32_16x16x32_bf16 v[40:43], v[20:23], v[192:195], v[40:43]
  v_mfma_f32_16x16x32_bf16 v[48:51], v[20:23], v[240:243], v[48:51]
  s_waitcnt lgkmcnt(1)
  v_mfma_f32_16x16x32_bf16 v[52:55], v[56:59], v[240:243], v[52:55]
  ds_read_b128 v[20:23], v62 offset:19456
  v_mfma_f32_16x16x32_bf16 v[44:47], v[56:59], v[192:195], v[44:47]
  v_mfma_f32_16x16x32_bf16 v[36:39], v[56:59], v[144:147], v[36:39]
  v_mfma_f32_16x16x32_bf16 v[28:31], v[56:59], v[96:99], v[28:31]
  s_waitcnt lgkmcnt(1)
  v_mfma_f32_16x16x32_bf16 v[24:27], v[16:19], v[100:103], v[24:27]
  ds_read_b128 v[56:59], v62 offset:20480
  v_mfma_f32_16x16x32_bf16 v[32:35], v[16:19], v[148:151], v[32:35]
  v_mfma_f32_16x16x32_bf16 v[40:43], v[16:19], v[196:199], v[40:43]
  v_mfma_f32_16x16x32_bf16 v[48:51], v[16:19], v[244:247], v[48:51]
  s_waitcnt lgkmcnt(1)
  v_mfma_f32_16x16x32_bf16 v[52:55], v[20:23], v[244:247], v[52:55]
  ds_read_b128 v[16:19], v62 offset:21504
  v_mfma_f32_16x16x32_bf16 v[44:47], v[20:23], v[196:199], v[44:47]
  v_mfma_f32_16x16x32_bf16 v[36:39], v[20:23], v[148:151], v[36:39]
  v_mfma_f32_16x16x32_bf16 v[28:31], v[20:23], v[100:103], v[28:31]
  s_waitcnt lgkmcnt(1)
  v_mfma_f32_16x16x32_bf16 v[24:27], v[56:59], v[104:107], v[24:27]
  ds_read_b128 v[20:23], v62 offset:22528
  v_mfma_f32_16x16x32_bf16 v[32:35], v[56:59], v[152:155], v[32:35]
  v_mfma_f32_16x16x32_bf16 v[40:43], v[56:59], v[200:203], v[40:43]
  v_mfma_f32_16x16x32_bf16 v[48:51], v[56:59], v[248:251], v[48:51]
  s_waitcnt lgkmcnt(1)
  v_mfma_f32_16x16x32_bf16 v[52:55], v[16:19], v[248:251], v[52:55]
  ds_read_b128 v[56:59], v62 offset:23552
  v_mfma_f32_16x16x32_bf16 v[44:47], v[16:19], v[200:203], v[44:47]
  v_mfma_f32_16x16x32_bf16 v[36:39], v[16:19], v[152:155], v[36:39]
  v_mfma_f32_16x16x32_bf16 v[28:31], v[16:19], v[104:107], v[28:31]
  s_waitcnt lgkmcnt(1)
  v_mfma_f32_16x16x32_bf16 v[24:27], v[20:23], v[108:111], v[24:27]
  v_mfma_f32_16x16x32_bf16 v[32:35], v[20:23], v[156:159], v[32:35]
  v_mfma_f32_16x16x32_bf16 v[40:43], v[20:23], v[204:207], v[40:43]
  v_mfma_f32_16x16x32_bf16 v[48:51], v[20:23], v[252:255], v[48:51]
  s_waitcnt lgkmcnt(0)
  v_mfma_f32_16x16x32_bf16 v[52:55], v[56:59], v[252:255], v[52:55]
  v_mfma_f32_16x16x32_bf16 v[44:47], v[56:59], v[204:207], v[44:47]
  v_mfma_f32_16x16x32_bf16 v[36:39], v[56:59], v[156:159], v[36:39]
  v_mfma_f32_16x16x32_bf16 v[28:31], v[56:59], v[108:111], v[28:31]
  s_setprio 0
  s_nop 4
  s_waitcnt vmcnt(1)
  v_lshlrev_b32 v61, 16, v12
  v_add_f32 v48, v48, v61
  v_and_b32 v12, 0xffff0000, v12
  v_add_f32 v49, v49, v12
  v_cvt_pk_bf16_f32 v48, v48, v49
  v_lshlrev_b32 v61, 16, v13
  v_add_f32 v50, v50, v61
  v_and_b32 v13, 0xffff0000, v13
  v_add_f32 v51, v51, v13
  v_cvt_pk_bf16_f32 v49, v50, v51
  v_lshlrev_b32 v61, 16, v14
  v_add_f32 v52, v52, v61
  v_and_b32 v14, 0xffff0000, v14
  v_add_f32 v53, v53, v14
  v_cvt_pk_bf16_f32 v50, v52, v53
  v_lshlrev_b32 v61, 16, v15
  v_add_f32 v54, v54, v61
  v_and_b32 v15, 0xffff0000, v15
  v_add_f32 v55, v55, v15
  v_cvt_pk_bf16_f32 v51, v54, v55
  buffer_store_dwordx4 v[48:51], v60, s[8:11], s63 offen offset:128 sc1
  v_lshlrev_b32 v61, 16, v8
  v_add_f32 v40, v40, v61
  v_and_b32 v8, 0xffff0000, v8
  v_add_f32 v41, v41, v8
  v_cvt_pk_bf16_f32 v40, v40, v41
  v_lshlrev_b32 v61, 16, v9
  v_add_f32 v42, v42, v61
  v_and_b32 v9, 0xffff0000, v9
  v_add_f32 v43, v43, v9
  v_cvt_pk_bf16_f32 v41, v42, v43
  v_lshlrev_b32 v61, 16, v10
  v_add_f32 v44, v44, v61
  v_and_b32 v10, 0xffff0000, v10
  v_add_f32 v45, v45, v10
  v_cvt_pk_bf16_f32 v42, v44, v45
  v_lshlrev_b32 v61, 16, v11
  v_add_f32 v46, v46, v61
  v_and_b32 v11, 0xffff0000, v11
  v_add_f32 v47, v47, v11
  v_cvt_pk_bf16_f32 v43, v46, v47
  buffer_store_dwordx4 v[40:43], v60, s[8:11], s62 offen offset:128 sc1
  v_lshlrev_b32 v61, 16, v4
  v_add_f32 v32, v32, v61
  v_and_b32 v4, 0xffff0000, v4
  v_add_f32 v33, v33, v4
  v_cvt_pk_bf16_f32 v32, v32, v33
  v_lshlrev_b32 v61, 16, v5
  v_add_f32 v34, v34, v61
  v_and_b32 v5, 0xffff0000, v5
  v_add_f32 v35, v35, v5
  v_cvt_pk_bf16_f32 v33, v34, v35
  v_lshlrev_b32 v61, 16, v6
  v_add_f32 v36, v36, v61
  v_and_b32 v6, 0xffff0000, v6
  v_add_f32 v37, v37, v6
  v_cvt_pk_bf16_f32 v34, v36, v37
  v_lshlrev_b32 v61, 16, v7
  v_add_f32 v38, v38, v61
  v_and_b32 v7, 0xffff0000, v7
  v_add_f32 v39, v39, v7
  v_cvt_pk_bf16_f32 v35, v38, v39
  s_cmp_ge_u32 s40, 4
  s_cbranch_scc1 L_RMX2
  buffer_load_dwordx4 v[44:47], v60, s[4:7], s82 offen offset:320
L_RMX2:
  buffer_store_dwordx4 v[32:35], v60, s[8:11], s61 offen offset:128 sc1
  v_lshlrev_b32 v61, 16, v0
  v_add_f32 v24, v24, v61
  v_and_b32 v0, 0xffff0000, v0
  v_add_f32 v25, v25, v0
  v_cvt_pk_bf16_f32 v24, v24, v25
  v_lshlrev_b32 v61, 16, v1
  v_add_f32 v26, v26, v61
  v_and_b32 v1, 0xffff0000, v1
  v_add_f32 v27, v27, v1
  v_cvt_pk_bf16_f32 v25, v26, v27
  v_lshlrev_b32 v61, 16, v2
  v_add_f32 v28, v28, v61
  v_and_b32 v2, 0xffff0000, v2
  v_add_f32 v29, v29, v2
  v_cvt_pk_bf16_f32 v26, v28, v29
  v_lshlrev_b32 v61, 16, v3
  v_add_f32 v30, v30, v61
  v_and_b32 v3, 0xffff0000, v3
  v_add_f32 v31, v31, v3
  v_cvt_pk_bf16_f32 v27, v30, v31
  buffer_store_dwordx4 v[24:27], v60, s[8:11], s60 offen offset:128 sc1
  s_cmp_ge_u32 s40, 4
  s_cbranch_scc1 L_RMN2
  v_and_b32 v61, 0x30, v60
  v_lshl_add_u32 v61, v61, 1, s57
  v_xor_b32 v37, 32, v63
  v_add_u32 v37, 256, v37
  ds_read_b128 v[48:51], v61 offset:2304
  ds_read_b128 v[52:55], v61 offset:2320
  ds_read_b64_tr_b16 v[24:25], v63 offset:0
  ds_read_b64_tr_b16 v[26:27], v37 offset:0
  ds_read_b128 v[16:19], v62 offset:0
  ds_read_b128 v[20:23], v62 offset:1024
  ds_read_b64_tr_b16 v[28:29], v63 offset:2048
  ds_read_b64_tr_b16 v[30:31], v37 offset:2048
  ds_read_b128 v[56:59], v62 offset:2048
  s_setprio 3
  s_waitcnt lgkmcnt(4)
  v_mfma_f32_16x16x32_bf16 v[48:51], v[16:19], v[24:27], v[48:51]
  ds_read_b64_tr_b16 v[32:33], v63 offset:4096
  ds_read_b64_tr_b16 v[34:35], v37 offset:4096
  ds_read_b128 v[40:43], v62 offset:3072
  s_waitcnt lgkmcnt(6)
  v_mfma_f32_16x16x32_bf16 v[52:55], v[20:23], v[24:27], v[52:55]
  ds_read_b128 v[16:19], v62 offset:4096
  s_waitcnt lgkmcnt(4)
  v_mfma_f32_16x16x32_bf16 v[48:51], v[56:59], v[28:31], v[48:51]
  ds_read_b64_tr_b16 v[24:25], v63 offset:6144
  ds_read_b64_tr_b16 v[26:27], v37 offset:6144
  ds_read_b128 v[20:23], v62 offset:5120
  s_waitcnt lgkmcnt(4)
  v_mfma_f32_16x16x32_bf16 v[52:55], v[40:43], v[28:31], v[52:55]
  ds_read_b128 v[56:59], v62 offset:6144
  s_waitcnt lgkmcnt(4)
  v_mfma_f32_16x16x32_bf16 v[48:51], v[16:19], v[32:35], v[48:51]
  ds_read_b64_tr_b16 v[28:29], v63 offset:8192
  ds_read_b64_tr_b16 v[30:31], v37 offset:8192
  ds_read_b128 v[40:43], v62 offset:7168
  s_waitcnt lgkmcnt(4)
  v_mfma_f32_16x16x32_bf16 v[52:55], v[20:23], v[32:35], v[52:55]
  ds_read_b128 v[16:19], v62 offset:8192
  s_waitcnt lgkmcnt(4)
  v_mfma_f32_16x16x32_bf16 v[48:51], v[56:59], v[24:27], v[48:51]
  ds_read_b64_tr_b16 v[32:33], v63 offset:10240
  ds_read_b64_tr_b16 v[34:35], v37 offset:10240
  ds_read_b128 v[20:23], v62 offset:9216
  s_waitcnt lgkmcnt(4)
  v_mfma_f32_16x16x32_bf16 v[52:55], v[40:43], v[24:27], v[52:55]
  ds_read_b128 v[56:59], v62 offset:10240
  s_waitcnt lgkmcnt(4)
  v_mfma_f32_16x16x32_bf16 v[48:51], v[16:19], v[28:31], v[48:51]
  ds_read_b64_tr_b16 v[24:25], v63 offset:12288
  ds_read_b64_tr_b16 v[26:27], v37 offset:12288
  ds_read_b128 v[40:43], v62 offset:11264
  s_waitcnt lgkmcnt(4)
  v_mfma_f32_16x16x32_bf16 v[52:55], v[20:23], v[28:31], v[52:55]
  ds_read_b128 v[16:19], v62 offset:12288
  s_waitcnt lgkmcnt(4)
  v_mfma_f32_16x16x32_bf16 v[48:51], v[56:59], v[32:35], v[48:51]
  ds_read_b64_tr_b16 v[28:29], v63 offset:14336
  ds_read_b64_tr_b16 v[30:31], v37 offset:14336
  ds_read_b128 v[20:23], v62 offset:13312
  s_waitcnt lgkmcnt(4)
  v_mfma_f32_16x16x32_bf16 v[52:55], v[40:43], v[32:35], v[52:55]
  ds_read_b128 v[56:59], v62 offset:14336
  s_waitcnt lgkmcnt(4)
  v_mfma_f32_16x16x32_bf16 v[48:51], v[16:19], v[24:27], v[48:51]
  ds_read_b64_tr_b16 v[32:33], v63 offset:16384
  ds_read_b64_tr_b16 v[34:35], v37 offset:16384
  ds_read_b128 v[40:43], v62 offset:15360
  s_waitcnt lgkmcnt(4)
  v_mfma_f32_16x16x32_bf16 v[52:55], v[20:23], v[24:27], v[52:55]
  ds_read_b128 v[16:19], v62 offset:16384
  s_waitcnt lgkmcnt(4)
  v_mfma_f32_16x16x32_bf16 v[48:51], v[56:59], v[28:31], v[48:51]
  ds_read_b64_tr_b16 v[24:25], v63 offset:18432
  ds_read_b64_tr_b16 v[26:27], v37 offset:18432
  ds_read_b128 v[20:23], v62 offset:17408
  s_waitcnt lgkmcnt(4)
  v_mfma_f32_16x16x32_bf16 v[52:55], v[40:43], v[28:31], v[52:55]
  ds_read_b128 v[56:59], v62 offset:18432
  s_waitcnt lgkmcnt(4)
  v_mfma_f32_16x16x32_bf16 v[48:51], v[16:19], v[32:35], v[48:51]
  ds_read_b64_tr_b16 v[28:29], v63 offset:20480
  ds_read_b64_tr_b16 v[30:31], v37 offset:20480
  ds_read_b128 v[40:43], v62 offset:19456
  s_waitcnt lgkmcnt(4)
  v_mfma_f32_16x16x32_bf16 v[52:55], v[20:23], v[32:35], v[52:55]
  ds_read_b128 v[16:19], v62 offset:20480
  s_waitcnt lgkmcnt(4)
  v_mfma_f32_16x16x32_bf16 v[48:51], v[56:59], v[24:27], v[48:51]
  ds_read_b64_tr_b16 v[32:33], v63 offset:22528
  ds_read_b64_tr_b16 v[34:35], v37 offset:22528
  ds_read_b128 v[20:23], v62 offset:21504
  s_waitcnt lgkmcnt(4)
  v_mfma_f32_16x16x32_bf16 v[52:55], v[40:43], v[24:27], v[52:55]
  ds_read_b128 v[56:59], v62 offset:22528
  s_waitcnt lgkmcnt(4)
  v_mfma_f32_16x16x32_bf16 v[48:51], v[16:19], v[28:31], v[48:51]
  ds_read_b128 v[40:43], v62 offset:23552
  s_waitcnt lgkmcnt(2)
  v_mfma_f32_16x16x32_bf16 v[52:55], v[20:23], v[28:31], v[52:55]
  s_waitcnt lgkmcnt(1)
  v_mfma_f32_16x16x32_bf16 v[48:51], v[56:59], v[32:35], v[48:51]
  s_waitcnt lgkmcnt(0)
  v_mfma_f32_16x16x32_bf16 v[52:55], v[40:43], v[32:35], v[52:55]
  s_setprio 0
  s_nop 6
  s_waitcnt vmcnt(2)
  v_lshlrev_b32 v61, 16, v44
  v_add_f32 v48, v48, v61
  v_and_b32 v44, 0xffff0000, v44
  v_add_f32 v49, v49, v44
  v_cvt_pk_bf16_f32 v48, v48, v49
  v_lshlrev_b32 v61, 16, v45
  v_add_f32 v50, v50, v61
  v_and_b32 v45, 0xffff0000, v45
  v_add_f32 v51, v51, v45
  v_cvt_pk_bf16_f32 v49, v50, v51
  v_lshlrev_b32 v61, 16, v46
  v_add_f32 v52, v52, v61
  v_and_b32 v46, 0xffff0000, v46
  v_add_f32 v53, v53, v46
  v_cvt_pk_bf16_f32 v50, v52, v53
  v_lshlrev_b32 v61, 16, v47
  v_add_f32 v54, v54, v61
  v_and_b32 v47, 0xffff0000, v47
  v_add_f32 v55, v55, v47
  v_cvt_pk_bf16_f32 v51, v54, v55
  buffer_store_dwordx4 v[48:51], v60, s[8:11], s82 offen offset:128 sc1
L_RMN2:
  s_branch L_FIN
L_HP2:
  s_mul_i32 s45, s41, 6144
  s_add_u32 s45, s45, 49152
  v_add_u32 v56, s45, v62
  s_mul_i32 s45, s41, 384
  s_add_u32 s45, s45, 147456
  v_and_b32 v57, 0x30, v60
  v_lshl_add_u32 v57, v57, 1, s45
  ds_read_b128 v[48:51], v57 offset:0
  ds_read_b128 v[52:55], v57 offset:16
  ds_read_b128 v[16:19], v57 offset:128
  ds_read_b128 v[20:23], v57 offset:144
  ds_read_b128 v[24:27], v56 offset:0
  ds_read_b128 v[28:31], v56 offset:1024
  ds_read_b128 v[32:35], v56 offset:2048
  ds_read_b128 v[36:39], v56 offset:3072
  ds_read_b128 v[40:43], v56 offset:4096
  ds_read_b128 v[44:47], v56 offset:5120
  s_waitcnt lgkmcnt(0)
  v_lshlrev_b32 v61, 16, v24
  v_and_b32 v58, 0xffff0000, v24
  v_mul_f32 v61, v61, v48
  v_mul_f32 v58, v58, v49
  v_cvt_pk_bf16_f32 v24, v61, v58
  v_lshlrev_b32 v61, 16, v25
  v_and_b32 v58, 0xffff0000, v25
  v_mul_f32 v61, v61, v50
  v_mul_f32 v58, v58, v51
  v_cvt_pk_bf16_f32 v25, v61, v58
  v_lshlrev_b32 v61, 16, v26
  v_and_b32 v58, 0xffff0000, v26
  v_mul_f32 v61, v61, v52
  v_mul_f32 v58, v58, v53
  v_cvt_pk_bf16_f32 v26, v61, v58
  v_lshlrev_b32 v61, 16, v27
  v_and_b32 v58, 0xffff0000, v27
  v_mul_f32 v61, v61, v54
  v_mul_f32 v58, v58, v55
  v_cvt_pk_bf16_f32 v27, v61, v58
  ds_write_b128 v56, v[24:27] offset:0
  v_lshlrev_b32 v61, 16, v28
  v_and_b32 v58, 0xffff0000, v28
  v_mul_f32 v61, v61, v48
  v_mul_f32 v58, v58, v49
  v_cvt_pk_bf16_f32 v28, v61, v58
  v_lshlrev_b32 v61, 16, v29
  v_and_b32 v58, 0xffff0000, v29
  v_mul_f32 v61, v61, v50
  v_mul_f32 v58, v58, v51
  v_cvt_pk_bf16_f32 v29, v61, v58
  v_lshlrev_b32 v61, 16, v30
  v_and_b32 v58, 0xffff0000, v30
  v_mul_f32 v61, v61, v52
  v_mul_f32 v58, v58, v53
  v_cvt_pk_bf16_f32 v30, v61, v58
  v_lshlrev_b32 v61, 16, v31
  v_and_b32 v58, 0xffff0000, v31
  v_mul_f32 v61, v61, v54
  v_mul_f32 v58, v58, v55
  v_cvt_pk_bf16_f32 v31, v61, v58
  ds_read_b128 v[48:51], v57 offset:256
  ds_read_b128 v[52:55], v57 offset:272
  ds_write_b128 v56, v[28:31] offset:1024
  v_lshlrev_b32 v61, 16, v32
  v_and_b32 v58, 0xffff0000, v32
  v_mul_f32 v61, v61, v16
  v_mul_f32 v58, v58, v17
  v_cvt_pk_bf16_f32 v32, v61, v58
  v_lshlrev_b32 v61, 16, v33
  v_and_b32 v58, 0xffff0000, v33
  v_mul_f32 v61, v61, v18
  v_mul_f32 v58, v58, v19
  v_cvt_pk_bf16_f32 v33, v61, v58
  v_lshlrev_b32 v61, 16, v34
  v_and_b32 v58, 0xffff0000, v34
  v_mul_f32 v61, v61, v20
  v_mul_f32 v58, v58, v21
  v_cvt_pk_bf16_f32 v34, v61, v58
  v_lshlrev_b32 v61, 16, v35
  v_and_b32 v58, 0xffff0000, v35
  v_mul_f32 v61, v61, v22
  v_mul_f32 v58, v58, v23
  v_cvt_pk_bf16_f32 v35, v61, v58
  ds_write_b128 v56, v[32:35] offset:2048
  v_lshlrev_b32 v61, 16, v36
  v_and_b32 v58, 0xffff0000, v36
  v_mul_f32 v61, v61, v16
  v_mul_f32 v58, v58, v17
  v_cvt_pk_bf16_f32 v36, v61, v58
  v_lshlrev_b32 v61, 16, v37
  v_and_b32 v58, 0xffff0000, v37
  v_mul_f32 v61, v61, v18
  v_mul_f32 v58, v58, v19
  v_cvt_pk_bf16_f32 v37, v61, v58
  v_lshlrev_b32 v61, 16, v38
  v_and_b32 v58, 0xffff0000, v38
  v_mul_f32 v61, v61, v20
  v_mul_f32 v58, v58, v21
  v_cvt_pk_bf16_f32 v38, v61, v58
  v_lshlrev_b32 v61, 16, v39
  v_and_b32 v58, 0xffff0000, v39
  v_mul_f32 v61, v61, v22
  v_mul_f32 v58, v58, v23
  v_cvt_pk_bf16_f32 v39, v61, v58
  ds_write_b128 v56, v[36:39] offset:3072
  s_waitcnt lgkmcnt(3)
  v_lshlrev_b32 v61, 16, v40
  v_and_b32 v58, 0xffff0000, v40
  v_mul_f32 v61, v61, v48
  v_mul_f32 v58, v58, v49
  v_cvt_pk_bf16_f32 v40, v61, v58
  v_lshlrev_b32 v61, 16, v41
  v_and_b32 v58, 0xffff0000, v41
  v_mul_f32 v61, v61, v50
  v_mul_f32 v58, v58, v51
  v_cvt_pk_bf16_f32 v41, v61, v58
  v_lshlrev_b32 v61, 16, v42
  v_and_b32 v58, 0xffff0000, v42
  v_mul_f32 v61, v61, v52
  v_mul_f32 v58, v58, v53
  v_cvt_pk_bf16_f32 v42, v61, v58
  v_lshlrev_b32 v61, 16, v43
  v_and_b32 v58, 0xffff0000, v43
  v_mul_f32 v61, v61, v54
  v_mul_f32 v58, v58, v55
  v_cvt_pk_bf16_f32 v43, v61, v58
  ds_write_b128 v56, v[40:43] offset:4096
  v_lshlrev_b32 v61, 16, v44
  v_and_b32 v58, 0xffff0000, v44
  v_mul_f32 v61, v61, v48
  v_mul_f32 v58, v58, v49
  v_cvt_pk_bf16_f32 v44, v61, v58
  v_lshlrev_b32 v61, 16, v45
  v_and_b32 v58, 0xffff0000, v45
  v_mul_f32 v61, v61, v50
  v_mul_f32 v58, v58, v51
  v_cvt_pk_bf16_f32 v45, v61, v58
  v_lshlrev_b32 v61, 16, v46
  v_and_b32 v58, 0xffff0000, v46
  v_mul_f32 v61, v61, v52
  v_mul_f32 v58, v58, v53
  v_cvt_pk_bf16_f32 v46, v61, v58
  v_lshlrev_b32 v61, 16, v47
  v_and_b32 v58, 0xffff0000, v47
  v_mul_f32 v61, v61, v54
  v_mul_f32 v58, v58, v55
  v_cvt_pk_bf16_f32 v47, v61, v58
  ds_write_b128 v56, v[44:47] offset:5120
  v_and_b32 v61, 0x30, v60
  v_lshl_add_u32 v61, v61, 1, s57
  ds_read_b128 v[24:27], v61 offset:2048
  ds_read_b128 v[28:31], v61 offset:2064
  ds_read_b128 v[32:35], v61 offset:2048
  ds_read_b128 v[36:39], v61 offset:2064
  ds_read_b128 v[40:43], v61 offset:2048
  ds_read_b128 v[44:47], v61 offset:2064
  ds_read_b128 v[48:51], v61 offset:2048
  ds_read_b128 v[52:55], v61 offset:2064
  s_branch L_RM
L_FIN:
L_END:
  s_endpgm
.section .rodata,"a"
.p2align 6
.amdhsa_kernel standalone__modern_conv_block_slak__vision_kernel
  .amdhsa_next_free_vgpr 256
  .amdhsa_next_free_sgpr 102
  .amdhsa_accum_offset 256
  .amdhsa_group_segment_fixed_size 0
  .amdhsa_kernarg_size 72
  .amdhsa_user_sgpr_count 2
  .amdhsa_user_sgpr_kernarg_segment_ptr 1
  .amdhsa_system_sgpr_workgroup_id_x 1
.end_amdhsa_kernel
```
